```python
import torch

def _softmax(x, axis=-1):
    return torch.softmax(x, dim=axis)

def _gelu(x):
    return torch.nn.functional.gelu(x, approximate='tanh')

def _silu(x):
    return torch.nn.functional.silu(x)

def _sigmoid(x):
    return torch.sigmoid(x)

def _layernorm(x, axis=-1, eps=1e-05):
    m = x.mean(dim=axis, keepdim=True)
    v = x.var(dim=axis, keepdim=True, unbiased=False)
    return (x - m) / torch.sqrt(v + eps)

def _scatter_add(tgt, idx, src, axis=0):
    return tgt.clone().index_add_(axis, idx, src)

def _segment_sum(src, seg, n):
    out = torch.zeros((n,) + src.shape[1:], dtype=src.dtype)
    return out.index_add_(0, seg, src)

def _pad(x, pw):
    flat = tuple((v for pair in reversed(pw) for v in pair))
    return torch.nn.functional.pad(x, flat)
kernel_name = 'adaLN_cond__sliding_block_cached__glu_gated_swiglu__decode'

def setup_inputs():

    _w = lambda a: (lambda t: t.to(torch.bfloat16) if t.is_floating_point() else t)(torch.as_tensor(a))

    def _A_setup():
        B, Sq, D = (8, 1, 448)
        Hq, Hkv, Sk, Dh = (16, 8, 4096, 256)
        assert Hq % Hkv == 0, (Hq, Hkv)
        return {'x': _w((lambda *s: torch.randn(*s, dtype=torch.bfloat16) * 0.1)(B, Sq, D)), 'k_cache': _w((lambda *s: torch.randn(*s, dtype=torch.bfloat16) * 0.8)(B, Hkv, Sk, Dh)), 'v_cache': _w((lambda *s: torch.randn(*s, dtype=torch.bfloat16) * 3.2)(B, Hkv, Sk, Dh)), 'wq': _w((lambda *s: torch.randn(*s, dtype=torch.bfloat16) * 0.8)(D, Hq * Dh) * D ** (-0.5)), 'wo': _w((lambda *s: torch.randn(*s, dtype=torch.bfloat16) * 3.2)(Hq * Dh, D) * (Hq * Dh) ** (-0.5))}
    _A_in = _A_setup()

    def _B_setup():
        B, S, D, F = (8, 1, 448, 1792)
        return {'x': _w((lambda *s: torch.randn(*s, dtype=torch.bfloat16) * 0.1)(B, S, D)), 'w1': _w((lambda *s: torch.randn(*s, dtype=torch.bfloat16) * 3.2)(D, F) * (2.0 / D) ** 0.5), 'w3': _w((lambda *s: torch.randn(*s, dtype=torch.bfloat16) * 3.2)(D, F) * (2.0 / D) ** 0.5), 'w2': _w((lambda *s: torch.randn(*s, dtype=torch.bfloat16) * 3.2)(F, D) * (2.0 / F) ** 0.5)}
    _B_in = _B_setup()
    return {'A_x': _A_in['x'], 'A_k_cache': _A_in['k_cache'], 'A_v_cache': _A_in['v_cache'], 'A_wq': _A_in['wq'], 'A_wo': _A_in['wo'], 'B_x': _B_in['x'], 'B_w1': _B_in['w1'], 'B_w3': _B_in['w3'], 'B_w2': _B_in['w2'], 'c': _w((lambda *s: torch.randn(*s, dtype=torch.bfloat16) * 0.8)(8, 448) * 8.0), 'w_mod': _w((lambda *s: torch.randn(*s, dtype=torch.bfloat16) * 0.8)(448, 6 * 448) * 448 ** (-0.5) * 8.0)}

def reference(A_x, A_k_cache, A_v_cache, A_wq, A_wo, B_x, B_w1, B_w3, B_w2, c, w_mod):

    def _A_ref(x, k_cache, v_cache, wq, wo):
        B, Sq, D = x.shape
        Hq, Dh = (16, 256)
        Hkv, Sk = (k_cache.shape[1], k_cache.shape[2])
        W = min(4096, max(256, Sk // 4))
        rep = Hq // Hkv
        q = (lambda x, *d: x.permute(*d))((x @ wq).reshape(B, Sq, Hq, Dh), 0, 2, 1, 3)
        k = (lambda x, n, axis: torch.repeat_interleave(x, n, dim=axis))(k_cache[:, :, Sk - W:, :], rep, axis=1)
        v = (lambda x, n, axis: torch.repeat_interleave(x, n, dim=axis))(v_cache[:, :, Sk - W:, :], rep, axis=1)
        scores = torch.einsum('bhqd,bhkd->bhqk', q, k) * Dh ** (-0.5)
        p = _softmax(scores, axis=-1)
        o = torch.einsum('bhqk,bhkd->bhqd', p, v)
        return (lambda x, *d: x.permute(*d))(o, 0, 2, 1, 3).reshape(B, Sq, Hq * Dh) @ wo

    def _B_ref(x, w1, w3, w2):
        gate = torch.einsum('bsd,df->bsf', x, w1)
        up = torch.einsum('bsd,df->bsf', x, w3)
        h = _silu(gate) * up
        out = torch.einsum('bsf,fd->bsd', h, w2)
        return out
    x = A_x
    mod = (_silu(c) @ w_mod).reshape(c.shape[0], 6, 1, -1)
    sa, ca, ga, sb, cb, gb = (mod[:, 0].clone(), mod[:, 1].clone(), mod[:, 2].clone(), mod[:, 3].clone(), mod[:, 4].clone(), mod[:, 5].clone())
    h = _layernorm(x, axis=-1) * (1 + ca) + sa
    x = x + ga * _A_ref(h, A_k_cache, A_v_cache, A_wq, A_wo)
    h = _layernorm(x, axis=-1) * (1 + cb) + sb
    x = x + gb * _B_ref(h, B_w1, B_w3, B_w2)
    return x
```

```asm
; @launch grid=(256,1,1) block=(768,1,1) lds=152320
.amdgcn_target "amdgcn-amd-amdhsa--gfx950"
.text
.globl adaLN_cond__sliding_block_cached__glu_gated_swiglu__decode_kernel
.p2align 8
.type adaLN_cond__sliding_block_cached__glu_gated_swiglu__decode_kernel,@function
adaLN_cond__sliding_block_cached__glu_gated_swiglu__decode_kernel:
    s_cmp_ge_u32 s2, 256
    s_cbranch_scc1 L_END
    s_load_dwordx16 s[4:19], s[0:1], 0
    s_load_dwordx8 s[20:27], s[0:1], 64
    s_load_dwordx4 s[28:31], s[0:1], 96
    v_lshrrev_b32 v1, 6, v0
    s_nop 0
    v_readfirstlane_b32 s3, v1
    v_and_b32 v0, 63, v0
    s_and_b32 s41, s2, 7
    s_lshr_b32 s36, s2, 3
    s_mov_b32 s40, 0
    v_lshrrev_b32 v1, 4, v0
    v_and_b32 v2, 15, v0
    v_mov_b32 v3, 0
    v_mov_b32 v4, 1
    s_mov_b32 s68, 0x3db8aa3b
    s_cmp_eq_u32 s41, 0
    s_cbranch_scc1 L_TAILWG
    s_mul_i32 s36, s36, 7
    s_add_u32 s36, s36, s41
    s_sub_u32 s36, s36, 1
    s_cmp_lt_u32 s36, 32
    s_cbranch_scc1 L_CHAIN
    s_sub_u32 s41, s36, 32
    s_mul_i32 s42, s41, 781
    s_lshr_b32 s42, s42, 14
    s_mul_i32 s43, s42, 21
    s_sub_u32 s43, s41, s43
    s_mul_i32 s37, s43, 37
    s_lshr_b32 s37, s37, 8
    s_mul_i32 s44, s37, 5
    s_sub_u32 s44, s43, s44
    s_sub_u32 s45, s44, 7
    s_cmp_ge_u32 s44, 7
    s_cselect_b32 s44, s45, s44
    s_mul_i32 s36, s42, 7
    s_add_u32 s36, s36, s44
    s_cmp_ge_u32 s41, 189
    s_cselect_b32 s36, 63, s36
    s_cselect_b32 s37, s43, s37
    s_lshl_b32 s41, s37, 3
    s_add_u32 s41, s41, s3
    s_lshl_b32 s41, s41, 14
    s_lshl_b32 s66, s36, 21
    s_add_u32 s66, s66, 1572864
    s_add_u32 s41, s41, s66
    s_add_u32 s42, s41, 8192
    v_lshlrev_b32 v5, 9, v2
    v_lshl_add_u32 v5, v1, 4, v5
    v_lshlrev_b32 v6, 11, v1
    v_lshl_add_u32 v6, v2, 4, v6
    v_mov_b32 v8, 0
    v_mov_b32 v9, 0
    v_mov_b32 v10, 0
    v_mov_b32 v11, 0
    ds_write_b128 v3, v[8:11]
    ds_write_b128 v3, v[8:11] offset:16
    s_waitcnt lgkmcnt(0)
    s_mov_b32 s48, s6
    s_and_b32 s49, s7, 0xffff
    s_mov_b32 s50, 134217728
    s_mov_b32 s51, 0x20000
    s_cmp_ge_u32 s3, 8
    s_cbranch_scc1 L_DYN
    buffer_load_dwordx4 v[16:19], v5, s[48:51], s41 offen offset:0 nt
    buffer_load_dwordx4 v[20:23], v5, s[48:51], s41 offen offset:64 nt
    buffer_load_dwordx4 v[24:27], v5, s[48:51], s41 offen offset:128 nt
    buffer_load_dwordx4 v[28:31], v5, s[48:51], s41 offen offset:192 nt
    s_barrier
    s_mov_b32 s52, s8
    s_and_b32 s53, s9, 0xffff
    s_mov_b32 s54, 134217728
    s_mov_b32 s55, 0x20000
    buffer_load_dwordx4 v[32:35], v5, s[48:51], s41 offen offset:256 nt
    buffer_load_dwordx4 v[36:39], v5, s[48:51], s41 offen offset:320 nt
    buffer_load_dwordx4 v[40:43], v5, s[48:51], s41 offen offset:384 nt
    buffer_load_dwordx4 v[44:47], v5, s[48:51], s41 offen offset:448 nt
    buffer_load_dwordx4 v[48:51], v5, s[48:51], s42 offen offset:0 nt
    buffer_load_dwordx4 v[52:55], v5, s[48:51], s42 offen offset:64 nt
    buffer_load_dwordx4 v[56:59], v5, s[48:51], s42 offen offset:128 nt
    buffer_load_dwordx4 v[60:63], v5, s[48:51], s42 offen offset:192 nt
    buffer_load_dwordx4 v[64:67], v5, s[48:51], s42 offen offset:256 nt
    buffer_load_dwordx4 v[68:71], v5, s[48:51], s42 offen offset:320 nt
    buffer_load_dwordx4 v[72:75], v5, s[48:51], s42 offen offset:384 nt
    buffer_load_dwordx4 v[76:79], v5, s[48:51], s42 offen offset:448 nt
    buffer_load_dwordx4 v[80:83], v6, s[52:55], s41 offen offset:0 nt
    buffer_load_dwordx4 v[84:87], v6, s[52:55], s41 offen offset:256 nt
    buffer_load_dwordx4 v[88:91], v6, s[52:55], s41 offen offset:512 nt
    buffer_load_dwordx4 v[92:95], v6, s[52:55], s41 offen offset:768 nt
    buffer_load_dwordx4 v[96:99], v6, s[52:55], s41 offen offset:1024 nt
    buffer_load_dwordx4 v[100:103], v6, s[52:55], s41 offen offset:1280 nt
    buffer_load_dwordx4 v[104:107], v6, s[52:55], s41 offen offset:1536 nt
    buffer_load_dwordx4 v[108:111], v6, s[52:55], s41 offen offset:1792 nt
    buffer_load_dwordx4 v[112:115], v6, s[52:55], s42 offen offset:0 nt
    buffer_load_dwordx4 v[116:119], v6, s[52:55], s42 offen offset:256 nt
    s_cmp_lg_u32 s3, 4
    s_cbranch_scc1 L_NT0
    ds_write_b32 v3, v4 offset:16
L_NT0:
    buffer_load_dwordx4 v[120:123], v6, s[52:55], s42 offen offset:512 nt
    buffer_load_dwordx4 v[124:127], v6, s[52:55], s42 offen offset:768 nt
    buffer_load_dwordx4 v[128:131], v6, s[52:55], s42 offen offset:1024 nt
    buffer_load_dwordx4 v[132:135], v6, s[52:55], s42 offen offset:1280 nt
    buffer_load_dwordx4 v[136:139], v6, s[52:55], s42 offen offset:1536 nt
    buffer_load_dwordx4 v[140:143], v6, s[52:55], s42 offen offset:1792 nt
    s_cmp_lg_u32 s3, 5
    s_cbranch_scc1 L_NTQ
    ds_write_b32 v3, v4 offset:12
L_NTQ:
L_KVD:
    s_mov_b32 s32, s30
    s_and_b32 s33, s31, 0xffff
    s_mov_b32 s34, 536870912
    s_mov_b32 s35, 0x20000
    v_lshrrev_b32 v7, 3, v2
    v_lshlrev_b32 v7, 9, v7
    v_lshl_add_u32 v7, v1, 4, v7
    v_and_b32 v12, 1, v0
    v_cmp_eq_u32 vcc, 1, v12
    v_mov_b32 v13, 0xffff
    v_mov_b32 v14, 0xffff0000
    v_cndmask_b32 v13, v13, v14, vcc
    v_bfe_u32 v12, v0, 1, 2
    v_cmp_eq_u32 vcc, 0, v12
    s_nop 1
    v_cndmask_b32 v8, 0, v13, vcc
    v_cmp_eq_u32 vcc, 1, v12
    s_nop 1
    v_cndmask_b32 v9, 0, v13, vcc
    v_cmp_eq_u32 vcc, 2, v12
    s_nop 1
    v_cndmask_b32 v10, 0, v13, vcc
    v_cmp_eq_u32 vcc, 3, v12
    s_nop 1
    v_cndmask_b32 v11, 0, v13, vcc
    s_cmp_ge_u32 s3, 4
    s_cbranch_scc1 L_AQW
    s_lshl_b32 s43, s36, 10
    s_lshl_b32 s44, s3, 8
    s_add_u32 s43, s43, s44
    s_add_u32 s43, s43, 65536
    s_add_u32 s64, s30, s43
    s_addc_u32 s65, s31, 0
    s_cmp_eq_u32 s3, 0
    s_cbranch_scc1 L_AG0
L_AGL:
    ds_read_b32 v12, v3 offset:8
    s_waitcnt lgkmcnt(0)
    v_readfirstlane_b32 s45, v12
    s_nop 0
    s_cmp_lg_u32 s45, 0
    s_cbranch_scc1 L_AP0
    s_sleep 2
    s_add_u32 s40, s40, 1
    s_cmp_lt_u32 s40, 400000
    s_cbranch_scc1 L_AGL
    s_branch L_AP
L_AG0:
    s_and_b32 s44, s2, 1
    s_lshl_b32 s44, s44, 6
    s_add_u32 s44, s44, 128
L_AG:
    s_load_dword s45, s[28:29], s44 glc
    s_waitcnt lgkmcnt(0)
    s_cmp_lg_u32 s45, 0
    s_cbranch_scc1 L_AG1
    s_sleep 32
    s_add_u32 s40, s40, 1
    s_cmp_lt_u32 s40, 400000
    s_cbranch_scc1 L_AG
L_AG1:
    ds_write_b32 v3, v4 offset:8
L_AP0:
    s_sleep 4
    ds_read_b32 v12, v3 offset:12
    s_waitcnt lgkmcnt(0)
    v_readfirstlane_b32 s45, v12
    s_nop 0
    s_cmp_lg_u32 s45, 0
    s_cbranch_scc1 L_AP
    s_add_u32 s40, s40, 1
    s_cmp_lt_u32 s40, 400000
    s_cbranch_scc1 L_AP0
L_AP:
    s_load_dwordx16 s[4:19], s[64:65], 0 glc
    s_load_dwordx16 s[48:63], s[64:65], 64 glc
    s_load_dwordx16 s[84:99], s[64:65], 128 glc
    s_load_dwordx8 s[20:27], s[64:65], 192 glc
    s_load_dwordx8 s[76:83], s[64:65], 224 glc
    s_waitcnt lgkmcnt(0)
    s_max_u32 s45, s63, s83
    s_cmp_lg_u32 s45, -1
    s_cbranch_scc1 L_AF
L_AR:
    s_sleep 20
    s_add_u32 s40, s40, 1
    s_cmp_lt_u32 s40, 400000
    s_cbranch_scc1 L_AP
L_AF:
    v_writelane_b32 v12, s4, 0
    v_writelane_b32 v12, s5, 1
    v_writelane_b32 v12, s6, 2
    v_writelane_b32 v12, s7, 3
    v_writelane_b32 v12, s8, 4
    v_writelane_b32 v12, s9, 5
    v_writelane_b32 v12, s10, 6
    v_writelane_b32 v12, s11, 7
    v_writelane_b32 v12, s12, 8
    v_writelane_b32 v12, s13, 9
    v_writelane_b32 v12, s14, 10
    v_writelane_b32 v12, s15, 11
    v_writelane_b32 v12, s16, 12
    v_writelane_b32 v12, s17, 13
    v_writelane_b32 v12, s18, 14
    v_writelane_b32 v12, s19, 15
    v_writelane_b32 v12, s48, 16
    v_writelane_b32 v12, s49, 17
    v_writelane_b32 v12, s50, 18
    v_writelane_b32 v12, s51, 19
    v_writelane_b32 v12, s52, 20
    v_writelane_b32 v12, s53, 21
    v_writelane_b32 v12, s54, 22
    v_writelane_b32 v12, s55, 23
    v_writelane_b32 v12, s56, 24
    v_writelane_b32 v12, s57, 25
    v_writelane_b32 v12, s58, 26
    v_writelane_b32 v12, s59, 27
    v_writelane_b32 v12, s60, 28
    v_writelane_b32 v12, s61, 29
    v_writelane_b32 v12, s62, 30
    v_writelane_b32 v12, s63, 31
    v_writelane_b32 v12, s84, 32
    v_writelane_b32 v12, s85, 33
    v_writelane_b32 v12, s86, 34
    v_writelane_b32 v12, s87, 35
    v_writelane_b32 v12, s88, 36
    v_writelane_b32 v12, s89, 37
    v_writelane_b32 v12, s90, 38
    v_writelane_b32 v12, s91, 39
    v_writelane_b32 v12, s92, 40
    v_writelane_b32 v12, s93, 41
    v_writelane_b32 v12, s94, 42
    v_writelane_b32 v12, s95, 43
    v_writelane_b32 v12, s96, 44
    v_writelane_b32 v12, s97, 45
    v_writelane_b32 v12, s98, 46
    v_writelane_b32 v12, s99, 47
    v_writelane_b32 v12, s20, 48
    v_writelane_b32 v12, s21, 49
    v_writelane_b32 v12, s22, 50
    v_writelane_b32 v12, s23, 51
    v_writelane_b32 v12, s24, 52
    v_writelane_b32 v12, s25, 53
    v_writelane_b32 v12, s26, 54
    v_writelane_b32 v12, s27, 55
    v_writelane_b32 v12, s76, 56
    v_writelane_b32 v12, s77, 57
    v_writelane_b32 v12, s78, 58
    v_writelane_b32 v12, s79, 59
    v_writelane_b32 v12, s80, 60
    v_writelane_b32 v12, s81, 61
    v_writelane_b32 v12, s82, 62
    v_writelane_b32 v12, s83, 63
    v_cmp_eq_u32 vcc, -1, v12
    s_cbranch_vccz L_AW
    s_cmp_lt_u32 s40, 400000
    s_cbranch_scc1 L_AR
L_AW:
    s_lshl_b32 s44, s3, 8
    v_lshlrev_b32 v13, 2, v0
    v_add_u32 v13, s44, v13
    ds_write_b32 v13, v12 offset:64
    s_waitcnt lgkmcnt(0)
    s_mov_b64 exec, 1
    ds_add_u32 v3, v4 offset:0
    s_mov_b64 exec, -1
L_AQW:
    ds_read_b32 v12, v3 offset:0
    s_waitcnt lgkmcnt(0)
    v_readfirstlane_b32 s45, v12
    s_nop 0
    s_cmp_ge_u32 s45, 4
    s_cbranch_scc1 L_AQD
    s_sleep 2
    s_add_u32 s40, s40, 1
    s_cmp_lt_u32 s40, 400000
    s_cbranch_scc1 L_AQW
L_AQD:
    ds_read_b128 v[144:147], v7 offset:64
    ds_read_b128 v[148:151], v7 offset:128
    ds_read_b128 v[152:155], v7 offset:192
    ds_read_b128 v[156:159], v7 offset:256
    v_lshlrev_b32 v15, 4, v0
    v_lshlrev_b32 v14, 3, v0
    s_and_b32 s39, s36, 7
    s_lshr_b32 s38, s36, 3
    v_lshrrev_b32 v6, 5, v0
    v_lshlrev_b32 v6, 3, v6
    s_mul_i32 s66, s38, 3
    s_add_u32 s66, s66, s37
    s_lshl_b32 s66, s66, 10
    s_mul_i32 s43, s39, 24576
    s_add_u32 s66, s66, s43
    s_add_u32 s66, s66, 131072
    s_lshl_b32 s41, s38, 2
    s_add_u32 s41, s41, s37
    s_lshl_b32 s46, s41, 4
    s_lshl_b32 s43, s39, 9
    s_add_u32 s46, s46, s43
    s_add_u32 s46, s46, 327680
    s_mov_b32 s69, 12
    s_mov_b32 s45, 1
    s_waitcnt vmcnt(31) lgkmcnt(3)
    v_mfma_f32_16x16x32_bf16 v[160:163], v[16:19], v[144:147], 0
    ds_read_b128 v[144:147], v7 offset:320
    s_waitcnt vmcnt(30) lgkmcnt(3)
    v_mfma_f32_16x16x32_bf16 v[160:163], v[20:23], v[148:151], v[160:163]
    ds_read_b128 v[148:151], v7 offset:384
    s_waitcnt vmcnt(29) lgkmcnt(3)
    v_mfma_f32_16x16x32_bf16 v[160:163], v[24:27], v[152:155], v[160:163]
    ds_read_b128 v[152:155], v7 offset:448
    s_waitcnt vmcnt(28) lgkmcnt(3)
    v_mfma_f32_16x16x32_bf16 v[160:163], v[28:31], v[156:159], v[160:163]
    ds_read_b128 v[156:159], v7 offset:512
    s_waitcnt vmcnt(27) lgkmcnt(3)
    v_mfma_f32_16x16x32_bf16 v[160:163], v[32:35], v[144:147], v[160:163]
    ds_read_b128 v[144:147], v7 offset:64
    s_waitcnt vmcnt(26) lgkmcnt(3)
    v_mfma_f32_16x16x32_bf16 v[160:163], v[36:39], v[148:151], v[160:163]
    ds_read_b128 v[148:151], v7 offset:128
    s_waitcnt vmcnt(25) lgkmcnt(3)
    v_mfma_f32_16x16x32_bf16 v[160:163], v[40:43], v[152:155], v[160:163]
    ds_read_b128 v[152:155], v7 offset:192
    s_waitcnt vmcnt(24) lgkmcnt(3)
    v_mfma_f32_16x16x32_bf16 v[160:163], v[44:47], v[156:159], v[160:163]
    ds_read_b128 v[156:159], v7 offset:256
    s_waitcnt vmcnt(23) lgkmcnt(3)
    v_mfma_f32_16x16x32_bf16 v[164:167], v[48:51], v[144:147], 0
    ds_read_b128 v[144:147], v7 offset:320
    s_waitcnt vmcnt(22) lgkmcnt(3)
    v_mfma_f32_16x16x32_bf16 v[164:167], v[52:55], v[148:151], v[164:167]
    ds_read_b128 v[148:151], v7 offset:384
    s_waitcnt vmcnt(21) lgkmcnt(3)
    v_mfma_f32_16x16x32_bf16 v[164:167], v[56:59], v[152:155], v[164:167]
    ds_read_b128 v[152:155], v7 offset:448
    s_waitcnt vmcnt(20) lgkmcnt(3)
    v_mfma_f32_16x16x32_bf16 v[164:167], v[60:63], v[156:159], v[164:167]
    ds_read_b128 v[156:159], v7 offset:512
    v_cvt_pk_bf16_f32 v12, v160, v161
    v_lshlrev_b32 v160, 16, v12
    v_and_b32 v161, 0xffff0000, v12
    v_cvt_pk_bf16_f32 v12, v162, v163
    v_lshlrev_b32 v162, 16, v12
    v_and_b32 v163, 0xffff0000, v12
    v_max3_f32 v13, v160, v161, v162
    v_max_f32 v13, v13, v163
    s_waitcnt vmcnt(19) lgkmcnt(3)
    v_mfma_f32_16x16x32_bf16 v[164:167], v[64:67], v[144:147], v[164:167]
    s_waitcnt vmcnt(18) lgkmcnt(2)
    v_mfma_f32_16x16x32_bf16 v[164:167], v[68:71], v[148:151], v[164:167]
    s_waitcnt vmcnt(17) lgkmcnt(1)
    v_mfma_f32_16x16x32_bf16 v[164:167], v[72:75], v[152:155], v[164:167]
    s_waitcnt vmcnt(16) lgkmcnt(0)
    v_mfma_f32_16x16x32_bf16 v[164:167], v[76:79], v[156:159], v[164:167]
    s_nop 7
    v_cvt_pk_bf16_f32 v12, v164, v165
    v_lshlrev_b32 v164, 16, v12
    v_and_b32 v165, 0xffff0000, v12
    v_cvt_pk_bf16_f32 v12, v166, v167
    v_lshlrev_b32 v166, 16, v12
    v_and_b32 v167, 0xffff0000, v12
    v_max3_f32 v13, v13, v164, v165
    v_max3_f32 v12, v13, v166, v167
    v_mov_b32 v5, v12
    s_nop 1
    v_permlane32_swap_b32 v5, v12
    v_max_f32 v12, v12, v5
    v_mov_b32 v5, v12
    s_nop 1
    v_permlane16_swap_b32 v5, v12
    v_max_f32 v12, v12, v5
    v_sub_f32 v160, v160, v12
    v_sub_f32 v161, v161, v12
    v_sub_f32 v162, v162, v12
    v_sub_f32 v163, v163, v12
    v_sub_f32 v164, v164, v12
    v_sub_f32 v165, v165, v12
    v_sub_f32 v166, v166, v12
    v_sub_f32 v167, v167, v12
    v_mul_f32 v160, s68, v160
    v_mul_f32 v161, s68, v161
    v_mul_f32 v162, s68, v162
    v_mul_f32 v163, s68, v163
    v_mul_f32 v164, s68, v164
    v_mul_f32 v165, s68, v165
    v_mul_f32 v166, s68, v166
    v_mul_f32 v167, s68, v167
    v_exp_f32 v160, v160
    v_exp_f32 v161, v161
    v_exp_f32 v162, v162
    v_exp_f32 v163, v163
    v_exp_f32 v164, v164
    v_exp_f32 v165, v165
    v_exp_f32 v166, v166
    v_exp_f32 v167, v167
    v_cvt_pk_bf16_f32 v16, v160, v160
    v_cvt_pk_bf16_f32 v17, v161, v161
    v_cvt_pk_bf16_f32 v18, v162, v162
    v_cvt_pk_bf16_f32 v19, v163, v163
    v_cvt_pk_bf16_f32 v20, v164, v164
    v_cvt_pk_bf16_f32 v21, v165, v165
    v_cvt_pk_bf16_f32 v22, v166, v166
    v_cvt_pk_bf16_f32 v23, v167, v167
    v_and_b32 v24, v16, v8
    v_and_b32 v25, v16, v9
    v_and_b32 v26, v16, v10
    v_and_b32 v27, v16, v11
    s_waitcnt vmcnt(15)
    s_nop 0
    v_mfma_f32_16x16x32_bf16 v[40:43], v[24:27], v[80:83], 0
    s_waitcnt vmcnt(14)
    v_mfma_f32_16x16x32_bf16 v[44:47], v[24:27], v[84:87], 0
    v_add_f32 v13, v160, v161
    v_add_f32 v5, v162, v163
    v_add_f32 v50, v164, v165
    v_add_f32 v51, v166, v167
    v_and_b32 v28, v17, v8
    v_and_b32 v29, v17, v9
    v_and_b32 v30, v17, v10
    v_and_b32 v31, v17, v11
    s_waitcnt vmcnt(13)
    s_nop 0
    v_mfma_f32_16x16x32_bf16 v[40:43], v[28:31], v[88:91], v[40:43]
    s_waitcnt vmcnt(12)
    v_mfma_f32_16x16x32_bf16 v[44:47], v[28:31], v[92:95], v[44:47]
    v_add_f32 v13, v13, v5
    v_add_f32 v50, v50, v51
    v_add_f32 v13, v13, v50
    v_and_b32 v32, v18, v8
    v_and_b32 v33, v18, v9
    v_and_b32 v34, v18, v10
    v_and_b32 v35, v18, v11
    s_waitcnt vmcnt(11)
    s_nop 0
    v_mfma_f32_16x16x32_bf16 v[40:43], v[32:35], v[96:99], v[40:43]
    s_waitcnt vmcnt(10)
    v_mfma_f32_16x16x32_bf16 v[44:47], v[32:35], v[100:103], v[44:47]
    v_mov_b32 v5, v13
    s_nop 1
    v_permlane32_swap_b32 v5, v13
    v_add_f32 v13, v13, v5
    v_mov_b32 v5, v13
    s_nop 1
    v_permlane16_swap_b32 v5, v13
    v_add_f32 v13, v13, v5
    v_and_b32 v36, v19, v8
    v_and_b32 v37, v19, v9
    v_and_b32 v38, v19, v10
    v_and_b32 v39, v19, v11
    s_waitcnt vmcnt(9)
    s_nop 0
    v_mfma_f32_16x16x32_bf16 v[40:43], v[36:39], v[104:107], v[40:43]
    s_waitcnt vmcnt(8)
    v_mfma_f32_16x16x32_bf16 v[44:47], v[36:39], v[108:111], v[44:47]
    v_readlane_b32 s41, v12, 0
    v_readlane_b32 s42, v12, 8
    v_readlane_b32 s43, v13, 0
    v_readlane_b32 s44, v13, 8
    v_and_b32 v24, v20, v8
    v_and_b32 v25, v20, v9
    v_and_b32 v26, v20, v10
    v_and_b32 v27, v20, v11
    s_waitcnt vmcnt(7)
    s_nop 0
    v_mfma_f32_16x16x32_bf16 v[40:43], v[24:27], v[112:115], v[40:43]
    s_waitcnt vmcnt(6)
    v_mfma_f32_16x16x32_bf16 v[44:47], v[24:27], v[116:119], v[44:47]
    v_mov_b32 v48, s41
    v_mov_b32 v49, s43
    s_mov_b32 exec_lo, 0
    v_mov_b32 v48, s42
    v_mov_b32 v49, s44
    s_mov_b64 exec, -1
    v_and_b32 v28, v21, v8
    v_and_b32 v29, v21, v9
    v_and_b32 v30, v21, v10
    v_and_b32 v31, v21, v11
    s_waitcnt vmcnt(5)
    s_nop 0
    v_mfma_f32_16x16x32_bf16 v[40:43], v[28:31], v[120:123], v[40:43]
    s_waitcnt vmcnt(4)
    v_mfma_f32_16x16x32_bf16 v[44:47], v[28:31], v[124:127], v[44:47]
    v_and_b32 v32, v22, v8
    v_and_b32 v33, v22, v9
    v_and_b32 v34, v22, v10
    v_and_b32 v35, v22, v11
    s_waitcnt vmcnt(3)
    s_nop 0
    v_mfma_f32_16x16x32_bf16 v[40:43], v[32:35], v[128:131], v[40:43]
    s_waitcnt vmcnt(2)
    v_mfma_f32_16x16x32_bf16 v[44:47], v[32:35], v[132:135], v[44:47]
    v_and_b32 v36, v23, v8
    v_and_b32 v37, v23, v9
    v_and_b32 v38, v23, v10
    v_and_b32 v39, v23, v11
    s_waitcnt vmcnt(1)
    s_nop 0
    v_mfma_f32_16x16x32_bf16 v[40:43], v[36:39], v[136:139], v[40:43]
    s_waitcnt vmcnt(0)
    v_mfma_f32_16x16x32_bf16 v[44:47], v[36:39], v[140:143], v[44:47]
    s_setprio 3
L_MG:
    s_mov_b64 exec, 1
    ds_wrxchg_rtn_b32 v12, v3, v3 offset:4
    s_mov_b64 exec, -1
    s_waitcnt lgkmcnt(0)
    v_readfirstlane_b32 s41, v12
    s_nop 0
    s_cmp_eq_u32 s41, 0
    s_cbranch_scc1 L_MLEAVE
    s_and_b32 s42, s41, 0xffff
    s_lshr_b32 s41, s41, 16
    s_add_u32 s45, s45, s41
    v_add_u32 v12, s42, v14
    v_add_u32 v13, s42, v15
    ds_read_b64 v[60:61], v12 offset:2048
    ds_read_b128 v[52:55], v13
    ds_read_b128 v[56:59], v13 offset:1024
    s_waitcnt lgkmcnt(2)
    v_max_f32 v62, v48, v60
    v_sub_f32 v63, v48, v62
    v_sub_f32 v60, v60, v62
    v_mul_f32 v63, s68, v63
    v_mul_f32 v60, s68, v60
    v_exp_f32 v63, v63
    v_exp_f32 v60, v60
    v_mov_b32 v48, v62
    v_mul_f32 v49, v49, v63
    v_fmac_f32 v49, v61, v60
    v_mul_f32 v40, v40, v63
    v_mul_f32 v41, v41, v63
    v_mul_f32 v42, v42, v63
    v_mul_f32 v43, v43, v63
    v_mul_f32 v44, v44, v63
    v_mul_f32 v45, v45, v63
    v_mul_f32 v46, v46, v63
    v_mul_f32 v47, v47, v63
    s_waitcnt lgkmcnt(0)
    v_fmac_f32 v40, v52, v60
    v_fmac_f32 v41, v53, v60
    v_fmac_f32 v42, v54, v60
    v_fmac_f32 v43, v55, v60
    v_fmac_f32 v44, v56, v60
    v_fmac_f32 v45, v57, v60
    v_fmac_f32 v46, v58, v60
    v_fmac_f32 v47, v59, v60
    s_cmp_ge_u32 s45, s69
    s_cbranch_scc1 L_MPUB
    s_add_u32 s40, s40, 1
    s_cmp_lt_u32 s40, 400000
    s_cbranch_scc1 L_MG
    s_branch L_FIN
L_MLEAVE:
    s_mul_i32 s42, s3, 2560
    s_add_u32 s42, s42, 2048
    v_add_u32 v12, s42, v14
    v_add_u32 v13, s42, v15
    ds_write_b128 v13, v[40:43]
    ds_write_b128 v13, v[44:47] offset:1024
    ds_write_b64 v12, v[48:49] offset:2048
    s_lshl_b32 s41, s45, 16
    s_or_b32 s41, s41, s42
    v_mov_b32 v13, s41
    s_waitcnt lgkmcnt(0)
    s_mov_b64 exec, 1
    ds_cmpst_rtn_b32 v12, v3, v3, v13 offset:4
    s_mov_b64 exec, -1
    s_waitcnt lgkmcnt(0)
    v_readfirstlane_b32 s41, v12
    s_nop 0
    s_cmp_eq_u32 s41, 0
    s_cbranch_scc1 L_FIN
    s_add_u32 s40, s40, 1
    s_cmp_lt_u32 s40, 400000
    s_cbranch_scc1 L_MG
    s_branch L_FIN
L_MPUB:
    v_rcp_f32 v62, v49
    s_nop 0
    v_mul_f32 v40, v40, v62
    v_mul_f32 v41, v41, v62
    v_mul_f32 v42, v42, v62
    v_mul_f32 v43, v43, v62
    v_mul_f32 v44, v44, v62
    v_mul_f32 v45, v45, v62
    v_mul_f32 v46, v46, v62
    v_mul_f32 v47, v47, v62
    v_cvt_pk_bf16_f32 v52, v40, v41
    v_min_u32 v52, -2, v52
    v_cvt_pk_bf16_f32 v53, v42, v43
    v_min_u32 v53, -2, v53
    v_cvt_pk_bf16_f32 v54, v44, v45
    v_min_u32 v54, -2, v54
    v_cvt_pk_bf16_f32 v55, v46, v47
    v_min_u32 v55, -2, v55
    buffer_store_dwordx4 v[52:55], v15, s[32:35], s66 offen sc1
    v_min_u32 v48, -2, v48
    v_min_u32 v49, -2, v49
    s_mov_b32 exec_lo, 1
    s_mov_b32 exec_hi, 1
    buffer_store_dwordx2 v[48:49], v6, s[32:35], s46 offen sc1
    s_branch L_FIN
L_DYN:
    s_barrier
    s_sub_u32 s43, s3, 8
    s_lshl_b32 s43, s43, 2
    v_mov_b32 v7, s43
    s_lshl_b32 s43, s36, 7
    s_add_u32 s43, s43, 331776
    s_add_u32 s64, s30, s43
    s_addc_u32 s65, s31, 0
    s_mov_b32 s52, s8
    s_and_b32 s53, s9, 0xffff
    s_mov_b32 s54, 134217728
    s_mov_b32 s55, 0x20000
L_DW:
    s_sleep 2
    ds_read_b32 v12, v7 offset:16
    ds_read_b32 v13, v3 offset:8
    s_waitcnt lgkmcnt(0)
    v_readfirstlane_b32 s45, v12
    v_readfirstlane_b32 s46, v13
    s_cmp_eq_u32 s45, 2
    s_cbranch_scc1 L_END
    s_and_b32 s45, s45, s46
    s_cbranch_scc1 L_DC
    s_add_u32 s40, s40, 1
    s_cmp_lt_u32 s40, 400000
    s_cbranch_scc1 L_DW
    s_endpgm
L_DC:
    s_mov_b32 s45, 1
    s_atomic_add s45, s[64:65], 0 glc
    s_waitcnt lgkmcnt(0)
    s_add_u32 s45, s45, 1
    s_cmp_ge_u32 s45, 8
    s_cbranch_scc1 L_DF
    s_add_u32 s41, s45, 24
    s_lshl_b32 s41, s41, 14
    s_add_u32 s41, s41, s66
    s_add_u32 s42, s41, 8192
    buffer_load_dwordx4 v[16:19], v5, s[48:51], s41 offen offset:0 nt
    buffer_load_dwordx4 v[20:23], v5, s[48:51], s41 offen offset:64 nt
    buffer_load_dwordx4 v[24:27], v5, s[48:51], s41 offen offset:128 nt
    buffer_load_dwordx4 v[28:31], v5, s[48:51], s41 offen offset:192 nt
    buffer_load_dwordx4 v[32:35], v5, s[48:51], s41 offen offset:256 nt
    buffer_load_dwordx4 v[36:39], v5, s[48:51], s41 offen offset:320 nt
    buffer_load_dwordx4 v[40:43], v5, s[48:51], s41 offen offset:384 nt
    buffer_load_dwordx4 v[44:47], v5, s[48:51], s41 offen offset:448 nt
    buffer_load_dwordx4 v[48:51], v5, s[48:51], s42 offen offset:0 nt
    buffer_load_dwordx4 v[52:55], v5, s[48:51], s42 offen offset:64 nt
    buffer_load_dwordx4 v[56:59], v5, s[48:51], s42 offen offset:128 nt
    buffer_load_dwordx4 v[60:63], v5, s[48:51], s42 offen offset:192 nt
    ds_write_b32 v7, v4 offset:20
    buffer_load_dwordx4 v[64:67], v5, s[48:51], s42 offen offset:256 nt
    buffer_load_dwordx4 v[68:71], v5, s[48:51], s42 offen offset:320 nt
    buffer_load_dwordx4 v[72:75], v5, s[48:51], s42 offen offset:384 nt
    buffer_load_dwordx4 v[76:79], v5, s[48:51], s42 offen offset:448 nt
    buffer_load_dwordx4 v[80:83], v6, s[52:55], s41 offen offset:0 nt
    buffer_load_dwordx4 v[84:87], v6, s[52:55], s41 offen offset:256 nt
    buffer_load_dwordx4 v[88:91], v6, s[52:55], s41 offen offset:512 nt
    buffer_load_dwordx4 v[92:95], v6, s[52:55], s41 offen offset:768 nt
    buffer_load_dwordx4 v[96:99], v6, s[52:55], s41 offen offset:1024 nt
    buffer_load_dwordx4 v[100:103], v6, s[52:55], s41 offen offset:1280 nt
    buffer_load_dwordx4 v[104:107], v6, s[52:55], s41 offen offset:1536 nt
    buffer_load_dwordx4 v[108:111], v6, s[52:55], s41 offen offset:1792 nt
    buffer_load_dwordx4 v[112:115], v6, s[52:55], s42 offen offset:0 nt
    buffer_load_dwordx4 v[116:119], v6, s[52:55], s42 offen offset:256 nt
    buffer_load_dwordx4 v[120:123], v6, s[52:55], s42 offen offset:512 nt
    buffer_load_dwordx4 v[124:127], v6, s[52:55], s42 offen offset:768 nt
    buffer_load_dwordx4 v[128:131], v6, s[52:55], s42 offen offset:1024 nt
    buffer_load_dwordx4 v[132:135], v6, s[52:55], s42 offen offset:1280 nt
    buffer_load_dwordx4 v[136:139], v6, s[52:55], s42 offen offset:1536 nt
    buffer_load_dwordx4 v[140:143], v6, s[52:55], s42 offen offset:1792 nt
    s_branch L_KVD
L_DF:
    v_mov_b32 v8, 2
    v_mov_b32 v9, 2
    v_mov_b32 v10, 2
    v_mov_b32 v11, 2
    ds_write_b128 v3, v[8:11] offset:16
    s_mov_b32 s32, s30
    s_and_b32 s33, s31, 0xffff
    s_mov_b32 s34, 536870912
    s_mov_b32 s35, 0x20000
    v_mov_b32 v40, 0
    v_mov_b32 v41, 0
    v_mov_b32 v42, 0
    v_mov_b32 v43, 0
    v_mov_b32 v44, 0
    v_mov_b32 v45, 0
    v_mov_b32 v46, 0
    v_mov_b32 v47, 0
    v_lshlrev_b32 v15, 4, v0
    v_lshlrev_b32 v14, 3, v0
    s_and_b32 s39, s36, 7
    s_lshr_b32 s38, s36, 3
    v_lshrrev_b32 v6, 5, v0
    v_lshlrev_b32 v6, 3, v6
    s_mul_i32 s66, s38, 3
    s_add_u32 s66, s66, s37
    s_lshl_b32 s66, s66, 10
    s_mul_i32 s43, s39, 24576
    s_add_u32 s66, s66, s43
    s_add_u32 s66, s66, 131072
    s_lshl_b32 s41, s38, 2
    s_add_u32 s41, s41, s37
    s_lshl_b32 s46, s41, 4
    s_lshl_b32 s43, s39, 9
    s_add_u32 s46, s46, s43
    s_add_u32 s46, s46, 327680
    s_mov_b32 s69, 12
    v_mov_b32 v48, 0xff800000
    v_mov_b32 v49, 0
    s_sub_u32 s45, 12, s3
    s_branch L_MG
L_CHAIN:
    s_waitcnt lgkmcnt(0)
    s_mov_b32 s32, s30
    s_and_b32 s33, s31, 0xffff
    s_mov_b32 s34, 536870912
    s_mov_b32 s35, 0x20000
    s_mov_b32 s52, s28
    s_and_b32 s53, s29, 0xffff
    s_mov_b32 s54, 256
    s_mov_b32 s55, 0x20000
    v_cmp_lt_u32 s[60:61], 7, v2
    v_lshlrev_b32 v15, 4, v0
    v_bfe_u32 v8, v0, 1, 2
    v_bfe_u32 v9, v0, 4, 2
    v_xor_b32 v8, v8, v9
    v_lshlrev_b32 v8, 5, v8
    v_and_b32 v9, 1, v0
    v_lshl_add_u32 v5, v9, 4, v8
    s_and_b32 s46, s3, 3
    v_bfe_u32 v8, v0, 2, 2
    v_lshl_add_u32 v6, v1, 2, v8
    v_mul_u32_u24 v7, 928, v6
    v_and_b32 v8, 3, v0
    v_lshl_add_u32 v7, v8, 4, v7
    v_and_b32 v14, 7, v2
    v_lshlrev_b32 v14, 4, v14
    v_lshl_add_u32 v14, v1, 7, v14
    s_mul_i32 s66, s36, 384
    s_sub_u32 s66, s66, 3584
    s_lshl_b32 s42, s36, 8
    s_cmp_ge_u32 s36, 28
    s_cselect_b32 s66, s42, s66
    s_lshl_b32 s67, s36, 7
    s_cmp_lt_u32 s3, 8
    s_cbranch_scc1 L_C8
    s_mov_b32 s48, s4
    s_and_b32 s49, s5, 0xffff
    s_mov_b32 s50, 7168
    s_mov_b32 s51, 0x20000
    s_setprio 3
    s_mul_i32 s42, s46, 1792
    buffer_load_dwordx4 v[16:19], v15, s[48:51], s42 offen
    buffer_load_dwordx4 v[20:23], v15, s[48:51], s42 offen offset:896
    v_mov_b32 v8, -1
    v_mov_b32 v9, -1
    v_mov_b32 v10, -1
    v_mov_b32 v11, -1
    s_cmp_ge_u32 s36, 7
    s_cbranch_scc1 L_CNP
    s_getpc_b64 s[64:65]
L_PCC:
    s_sub_u32 s64, s64, L_PCC-adaLN_cond__sliding_block_cached__glu_gated_swiglu__decode_kernel
    s_subb_u32 s65, s65, 0
    v_lshlrev_b32 v12, 7, v0
    s_lshl_b32 s41, s46, 13
    v_add_u32 v12, s41, v12
    v_cmp_gt_u32 vcc, L_CODE_END-adaLN_cond__sliding_block_cached__glu_gated_swiglu__decode_kernel, v12
    s_nop 0
    s_and_b64 exec, exec, vcc
    s_cbranch_execz L_NOPFC
    global_load_dword v13, v12, s[64:65]
L_NOPFC:
    s_mov_b64 exec, -1
L_CNP:
    s_cmp_lt_u32 s36, 14
    s_cbranch_scc1 L_CX
    s_cmp_eq_u32 s3, 9
    s_cbranch_scc1 L_CLQ
    s_cmp_lg_u32 s3, 8
    s_cbranch_scc1 L_CX
    s_cmp_lg_u32 s36, 28
    s_cbranch_scc1 L_CX
    s_mov_b32 s41, 0
L_CLM:
    buffer_store_dwordx4 v[8:11], v15, s[32:35], s41 offen offset:0 sc1
    buffer_store_dwordx4 v[8:11], v15, s[32:35], s41 offen offset:1024 sc1
    buffer_store_dwordx4 v[8:11], v15, s[32:35], s41 offen offset:2048 sc1
    buffer_store_dwordx4 v[8:11], v15, s[32:35], s41 offen offset:3072 sc1
    s_add_u32 s41, s41, 4096
    s_cmp_lt_u32 s41, 16384
    s_cbranch_scc1 L_CLM
    s_waitcnt vmcnt(0)
    s_mov_b64 exec, 1
    buffer_store_dword v4, v3, s[52:55], 0 offen offset:0 sc1
    s_mov_b64 exec, -1
    s_branch L_CX
L_CLQ:
    s_sub_u32 s41, s36, 14
    s_mul_i32 s41, s41, 15360
    s_add_u32 s41, s41, 65536
    buffer_store_dwordx4 v[8:11], v15, s[32:35], s41 offen offset:0 sc1
    buffer_store_dwordx4 v[8:11], v15, s[32:35], s41 offen offset:1024 sc1
    buffer_store_dwordx4 v[8:11], v15, s[32:35], s41 offen offset:2048 sc1
    buffer_store_dwordx4 v[8:11], v15, s[32:35], s41 offen offset:3072 sc1
    s_add_u32 s41, s41, 4096
    buffer_store_dwordx4 v[8:11], v15, s[32:35], s41 offen offset:0 sc1
    buffer_store_dwordx4 v[8:11], v15, s[32:35], s41 offen offset:1024 sc1
    buffer_store_dwordx4 v[8:11], v15, s[32:35], s41 offen offset:2048 sc1
    buffer_store_dwordx4 v[8:11], v15, s[32:35], s41 offen offset:3072 sc1
    s_add_u32 s41, s41, 4096
    buffer_store_dwordx4 v[8:11], v15, s[32:35], s41 offen offset:0 sc1
    buffer_store_dwordx4 v[8:11], v15, s[32:35], s41 offen offset:1024 sc1
    buffer_store_dwordx4 v[8:11], v15, s[32:35], s41 offen offset:2048 sc1
    buffer_store_dwordx4 v[8:11], v15, s[32:35], s41 offen offset:3072 sc1
    s_add_u32 s41, s41, 4096
    buffer_store_dwordx4 v[8:11], v15, s[32:35], s41 offen offset:0 sc1
    buffer_store_dwordx4 v[8:11], v15, s[32:35], s41 offen offset:1024 sc1
    buffer_store_dwordx4 v[8:11], v15, s[32:35], s41 offen offset:2048 sc1
    s_mov_b32 s42, 1
    s_waitcnt vmcnt(0)
    s_atomic_add s42, s[28:29], 156 glc
    s_waitcnt lgkmcnt(0)
    s_cmp_lg_u32 s42, 17
    s_cbranch_scc1 L_CX
    s_mov_b64 exec, 1
    buffer_store_dword v4, v3, s[52:55], 0 offen offset:128 sc1
    buffer_store_dword v4, v3, s[52:55], 0 offen offset:192 sc1
    buffer_store_dword v4, v3, s[52:55], 0 offen offset:8 sc1
    s_mov_b64 exec, -1
L_CX:
    s_waitcnt vmcnt(0)
    v_cmp_gt_u32 vcc, 56, v0
    s_nop 1
    v_cndmask_b32 v16, 0, v16, vcc
    v_lshlrev_b32 v36, 16, v16
    v_and_b32 v37, 0xffff0000, v16
    v_cndmask_b32 v17, 0, v17, vcc
    v_lshlrev_b32 v38, 16, v17
    v_and_b32 v39, 0xffff0000, v17
    v_cndmask_b32 v18, 0, v18, vcc
    v_lshlrev_b32 v40, 16, v18
    v_and_b32 v41, 0xffff0000, v18
    v_cndmask_b32 v19, 0, v19, vcc
    v_lshlrev_b32 v42, 16, v19
    v_and_b32 v43, 0xffff0000, v19
    v_add_f32 v8, v36, v37
    v_add_f32 v9, v38, v39
    v_add_f32 v12, v40, v41
    v_add_f32 v13, v42, v43
    v_add_f32 v8, v8, v9
    v_add_f32 v12, v12, v13
    v_add_f32 v8, v8, v12
    s_nop 1
    v_add_f32_dpp v8, v8, v8 row_shr:1 row_mask:0xf bank_mask:0xf bound_ctrl:0
    s_nop 1
    v_add_f32_dpp v8, v8, v8 row_shr:2 row_mask:0xf bank_mask:0xf bound_ctrl:0
    s_nop 1
    v_add_f32_dpp v8, v8, v8 row_shr:4 row_mask:0xf bank_mask:0xf bound_ctrl:0
    s_nop 1
    v_add_f32_dpp v8, v8, v8 row_shr:8 row_mask:0xf bank_mask:0xf bound_ctrl:0
    s_nop 1
    v_add_f32_dpp v8, v8, v8 row_bcast:15 row_mask:0xa bank_mask:0xf
    s_nop 1
    v_add_f32_dpp v8, v8, v8 row_bcast:31 row_mask:0xc bank_mask:0xf
    s_nop 0
    v_readlane_b32 s43, v8, 63
    v_mov_b32 v12, 0x3b124925
    s_nop 0
    v_mul_f32 v10, s43, v12
    v_sub_f32 v9, v36, v10
    v_mul_f32 v8, v9, v9
    v_sub_f32 v9, v37, v10
    v_fmac_f32 v8, v9, v9
    v_sub_f32 v9, v38, v10
    v_fmac_f32 v8, v9, v9
    v_sub_f32 v9, v39, v10
    v_fmac_f32 v8, v9, v9
    v_sub_f32 v9, v40, v10
    v_fmac_f32 v8, v9, v9
    v_sub_f32 v9, v41, v10
    v_fmac_f32 v8, v9, v9
    v_sub_f32 v9, v42, v10
    v_fmac_f32 v8, v9, v9
    v_sub_f32 v9, v43, v10
    v_fmac_f32 v8, v9, v9
    v_cndmask_b32 v8, 0, v8, vcc
    s_nop 1
    v_add_f32_dpp v8, v8, v8 row_shr:1 row_mask:0xf bank_mask:0xf bound_ctrl:0
    s_nop 1
    v_add_f32_dpp v8, v8, v8 row_shr:2 row_mask:0xf bank_mask:0xf bound_ctrl:0
    s_nop 1
    v_add_f32_dpp v8, v8, v8 row_shr:4 row_mask:0xf bank_mask:0xf bound_ctrl:0
    s_nop 1
    v_add_f32_dpp v8, v8, v8 row_shr:8 row_mask:0xf bank_mask:0xf bound_ctrl:0
    s_nop 1
    v_add_f32_dpp v8, v8, v8 row_bcast:15 row_mask:0xa bank_mask:0xf
    s_nop 1
    v_add_f32_dpp v8, v8, v8 row_bcast:31 row_mask:0xc bank_mask:0xf
    s_nop 0
    v_readlane_b32 s43, v8, 63
    s_nop 1
    v_mul_f32 v11, s43, v12
    v_cvt_pk_bf16_f32 v8, v10, v11
    v_lshlrev_b32 v10, 16, v8
    v_and_b32 v11, 0xffff0000, v8
    v_add_f32 v11, 0x3727c5ac, v11
    v_cvt_pk_bf16_f32 v11, v11, v11
    v_lshlrev_b32 v11, 16, v11
    v_sqrt_f32 v11, v11
    s_nop 0
    v_cvt_pk_bf16_f32 v11, v11, v11
    v_lshlrev_b32 v11, 16, v11
    v_rcp_f32 v11, v11
    v_sub_f32 v36, v36, v10
    v_sub_f32 v37, v37, v10
    v_sub_f32 v38, v38, v10
    v_sub_f32 v39, v39, v10
    v_sub_f32 v40, v40, v10
    v_sub_f32 v41, v41, v10
    v_sub_f32 v42, v42, v10
    v_sub_f32 v43, v43, v10
    v_cvt_pk_bf16_f32 v8, v36, v37
    v_lshlrev_b32 v36, 16, v8
    v_and_b32 v37, 0xffff0000, v8
    v_cvt_pk_bf16_f32 v8, v38, v39
    v_lshlrev_b32 v38, 16, v8
    v_and_b32 v39, 0xffff0000, v8
    v_cvt_pk_bf16_f32 v8, v40, v41
    v_lshlrev_b32 v40, 16, v8
    v_and_b32 v41, 0xffff0000, v8
    v_cvt_pk_bf16_f32 v8, v42, v43
    v_lshlrev_b32 v42, 16, v8
    v_and_b32 v43, 0xffff0000, v8
    v_mul_f32 v36, v36, v11
    v_mul_f32 v37, v37, v11
    v_cvt_pk_bf16_f32 v16, v36, v37
    v_mul_f32 v38, v38, v11
    v_mul_f32 v39, v39, v11
    v_cvt_pk_bf16_f32 v17, v38, v39
    v_mul_f32 v40, v40, v11
    v_mul_f32 v41, v41, v11
    v_cvt_pk_bf16_f32 v18, v40, v41
    v_mul_f32 v42, v42, v11
    v_mul_f32 v43, v43, v11
    v_cvt_pk_bf16_f32 v19, v42, v43
    v_cndmask_b32 v20, 0, v20, vcc
    v_lshlrev_b32 v36, 16, v20
    v_and_b32 v37, 0xffff0000, v20
    v_cndmask_b32 v21, 0, v21, vcc
    v_lshlrev_b32 v38, 16, v21
    v_and_b32 v39, 0xffff0000, v21
    v_cndmask_b32 v22, 0, v22, vcc
    v_lshlrev_b32 v40, 16, v22
    v_and_b32 v41, 0xffff0000, v22
    v_cndmask_b32 v23, 0, v23, vcc
    v_lshlrev_b32 v42, 16, v23
    v_and_b32 v43, 0xffff0000, v23
    v_add_f32 v8, v36, v37
    v_add_f32 v9, v38, v39
    v_add_f32 v12, v40, v41
    v_add_f32 v13, v42, v43
    v_add_f32 v8, v8, v9
    v_add_f32 v12, v12, v13
    v_add_f32 v8, v8, v12
    s_nop 1
    v_add_f32_dpp v8, v8, v8 row_shr:1 row_mask:0xf bank_mask:0xf bound_ctrl:0
    s_nop 1
    v_add_f32_dpp v8, v8, v8 row_shr:2 row_mask:0xf bank_mask:0xf bound_ctrl:0
    s_nop 1
    v_add_f32_dpp v8, v8, v8 row_shr:4 row_mask:0xf bank_mask:0xf bound_ctrl:0
    s_nop 1
    v_add_f32_dpp v8, v8, v8 row_shr:8 row_mask:0xf bank_mask:0xf bound_ctrl:0
    s_nop 1
    v_add_f32_dpp v8, v8, v8 row_bcast:15 row_mask:0xa bank_mask:0xf
    s_nop 1
    v_add_f32_dpp v8, v8, v8 row_bcast:31 row_mask:0xc bank_mask:0xf
    s_nop 0
    v_readlane_b32 s43, v8, 63
    v_mov_b32 v12, 0x3b124925
    s_nop 0
    v_mul_f32 v10, s43, v12
    v_sub_f32 v9, v36, v10
    v_mul_f32 v8, v9, v9
    v_sub_f32 v9, v37, v10
    v_fmac_f32 v8, v9, v9
    v_sub_f32 v9, v38, v10
    v_fmac_f32 v8, v9, v9
    v_sub_f32 v9, v39, v10
    v_fmac_f32 v8, v9, v9
    v_sub_f32 v9, v40, v10
    v_fmac_f32 v8, v9, v9
    v_sub_f32 v9, v41, v10
    v_fmac_f32 v8, v9, v9
    v_sub_f32 v9, v42, v10
    v_fmac_f32 v8, v9, v9
    v_sub_f32 v9, v43, v10
    v_fmac_f32 v8, v9, v9
    v_cndmask_b32 v8, 0, v8, vcc
    s_nop 1
    v_add_f32_dpp v8, v8, v8 row_shr:1 row_mask:0xf bank_mask:0xf bound_ctrl:0
    s_nop 1
    v_add_f32_dpp v8, v8, v8 row_shr:2 row_mask:0xf bank_mask:0xf bound_ctrl:0
    s_nop 1
    v_add_f32_dpp v8, v8, v8 row_shr:4 row_mask:0xf bank_mask:0xf bound_ctrl:0
    s_nop 1
    v_add_f32_dpp v8, v8, v8 row_shr:8 row_mask:0xf bank_mask:0xf bound_ctrl:0
    s_nop 1
    v_add_f32_dpp v8, v8, v8 row_bcast:15 row_mask:0xa bank_mask:0xf
    s_nop 1
    v_add_f32_dpp v8, v8, v8 row_bcast:31 row_mask:0xc bank_mask:0xf
    s_nop 0
    v_readlane_b32 s43, v8, 63
    s_nop 1
    v_mul_f32 v11, s43, v12
    v_cvt_pk_bf16_f32 v8, v10, v11
    v_lshlrev_b32 v10, 16, v8
    v_and_b32 v11, 0xffff0000, v8
    v_add_f32 v11, 0x3727c5ac, v11
    v_cvt_pk_bf16_f32 v11, v11, v11
    v_lshlrev_b32 v11, 16, v11
    v_sqrt_f32 v11, v11
    s_nop 0
    v_cvt_pk_bf16_f32 v11, v11, v11
    v_lshlrev_b32 v11, 16, v11
    v_rcp_f32 v11, v11
    v_sub_f32 v36, v36, v10
    v_sub_f32 v37, v37, v10
    v_sub_f32 v38, v38, v10
    v_sub_f32 v39, v39, v10
    v_sub_f32 v40, v40, v10
    v_sub_f32 v41, v41, v10
    v_sub_f32 v42, v42, v10
    v_sub_f32 v43, v43, v10
    v_cvt_pk_bf16_f32 v8, v36, v37
    v_lshlrev_b32 v36, 16, v8
    v_and_b32 v37, 0xffff0000, v8
    v_cvt_pk_bf16_f32 v8, v38, v39
    v_lshlrev_b32 v38, 16, v8
    v_and_b32 v39, 0xffff0000, v8
    v_cvt_pk_bf16_f32 v8, v40, v41
    v_lshlrev_b32 v40, 16, v8
    v_and_b32 v41, 0xffff0000, v8
    v_cvt_pk_bf16_f32 v8, v42, v43
    v_lshlrev_b32 v42, 16, v8
    v_and_b32 v43, 0xffff0000, v8
    v_mul_f32 v36, v36, v11
    v_mul_f32 v37, v37, v11
    v_cvt_pk_bf16_f32 v20, v36, v37
    v_mul_f32 v38, v38, v11
    v_mul_f32 v39, v39, v11
    v_cvt_pk_bf16_f32 v21, v38, v39
    v_mul_f32 v40, v40, v11
    v_mul_f32 v41, v41, v11
    v_cvt_pk_bf16_f32 v22, v40, v41
    v_mul_f32 v42, v42, v11
    v_mul_f32 v43, v43, v11
    v_cvt_pk_bf16_f32 v23, v42, v43
    s_cmp_ge_u32 s36, 14
    s_cbranch_scc1 L_SGQ
    s_cmp_lg_u32 s3, 8
    s_cbranch_scc1 L_SGAD
    s_branch L_SGA
L_SGQ:
    s_sleep 48
L_SGA:
    s_load_dword s42, s[28:29], 0 glc
    s_waitcnt lgkmcnt(0)
    s_cmp_lg_u32 s42, 0
    s_cbranch_scc1 L_SGAD
    s_sleep 6
    s_add_u32 s40, s40, 1
    s_cmp_lt_u32 s40, 400000
    s_cbranch_scc1 L_SGA
L_SGAD:
    s_cmp_ge_u32 s36, 14
    s_cbranch_scc1 L_HN
    s_barrier
    s_barrier
    s_barrier
L_HN:
    v_lshrrev_b32 v11, 2, v0
    v_lshlrev_b32 v11, 9, v11
    v_and_b32 v12, 1, v0
    v_lshl_add_u32 v11, v12, 8, v11
    v_bfe_u32 v12, v0, 1, 1
    v_lshl_add_u32 v11, v12, 3, v11
    s_lshl_b32 s42, s46, 5
    v_add_u32 v13, s42, v11
    s_lshl_b32 s41, s46, 12
    s_add_u32 s41, s41, 0
    s_mov_b32 exec_hi, 0x00ffffff
L_MU:
    buffer_load_dwordx4 v[24:27], v15, s[32:35], s41 offen offset:0 sc1
    buffer_load_dwordx4 v[28:31], v15, s[32:35], s41 offen offset:896 sc1
    buffer_load_dwordx4 v[32:35], v15, s[32:35], s41 offen offset:2048 sc1
    buffer_load_dwordx4 v[36:39], v15, s[32:35], s41 offen offset:2944 sc1
    s_waitcnt vmcnt(0)
    v_max3_u32 v8, v24, v25, v26
    v_max3_u32 v8, v8, v27, v28
    v_max3_u32 v8, v8, v29, v30
    v_max3_u32 v8, v8, v31, v32
    v_max3_u32 v8, v8, v33, v34
    v_max3_u32 v8, v8, v35, v36
    v_max3_u32 v8, v8, v37, v38
    v_max_u32 v8, v8, v39
    v_cmp_eq_u32 vcc, -1, v8
    s_cbranch_vccnz LR_1
LC_2:
    s_mov_b32 exec_lo, -1
    s_mov_b32 exec_hi, 0x00ffffff
    v_lshlrev_b32 v8, 16, v28
    v_and_b32 v9, 0xffff0000, v28
    v_add_f32 v8, 1.0, v8
    v_add_f32 v9, 1.0, v9
    v_cvt_pk_bf16_f32 v10, v8, v9
    v_lshlrev_b32 v8, 16, v10
    v_and_b32 v9, 0xffff0000, v10
    v_lshlrev_b32 v10, 16, v16
    v_and_b32 v11, 0xffff0000, v16
    v_mul_f32 v8, v8, v10
    v_mul_f32 v9, v9, v11
    v_cvt_pk_bf16_f32 v10, v8, v9
    v_lshlrev_b32 v8, 16, v10
    v_and_b32 v9, 0xffff0000, v10
    v_lshlrev_b32 v10, 16, v24
    v_and_b32 v11, 0xffff0000, v24
    v_add_f32 v8, v8, v10
    v_add_f32 v9, v9, v11
    v_cvt_pk_bf16_f32 v24, v8, v9
    v_lshlrev_b32 v8, 16, v29
    v_and_b32 v9, 0xffff0000, v29
    v_add_f32 v8, 1.0, v8
    v_add_f32 v9, 1.0, v9
    v_cvt_pk_bf16_f32 v10, v8, v9
    v_lshlrev_b32 v8, 16, v10
    v_and_b32 v9, 0xffff0000, v10
    v_lshlrev_b32 v10, 16, v17
    v_and_b32 v11, 0xffff0000, v17
    v_mul_f32 v8, v8, v10
    v_mul_f32 v9, v9, v11
    v_cvt_pk_bf16_f32 v10, v8, v9
    v_lshlrev_b32 v8, 16, v10
    v_and_b32 v9, 0xffff0000, v10
    v_lshlrev_b32 v10, 16, v25
    v_and_b32 v11, 0xffff0000, v25
    v_add_f32 v8, v8, v10
    v_add_f32 v9, v9, v11
    v_cvt_pk_bf16_f32 v25, v8, v9
    v_lshlrev_b32 v8, 16, v30
    v_and_b32 v9, 0xffff0000, v30
    v_add_f32 v8, 1.0, v8
    v_add_f32 v9, 1.0, v9
    v_cvt_pk_bf16_f32 v10, v8, v9
    v_lshlrev_b32 v8, 16, v10
    v_and_b32 v9, 0xffff0000, v10
    v_lshlrev_b32 v10, 16, v18
    v_and_b32 v11, 0xffff0000, v18
    v_mul_f32 v8, v8, v10
    v_mul_f32 v9, v9, v11
    v_cvt_pk_bf16_f32 v10, v8, v9
    v_lshlrev_b32 v8, 16, v10
    v_and_b32 v9, 0xffff0000, v10
    v_lshlrev_b32 v10, 16, v26
    v_and_b32 v11, 0xffff0000, v26
    v_add_f32 v8, v8, v10
    v_add_f32 v9, v9, v11
    v_cvt_pk_bf16_f32 v26, v8, v9
    v_lshlrev_b32 v8, 16, v31
    v_and_b32 v9, 0xffff0000, v31
    v_add_f32 v8, 1.0, v8
    v_add_f32 v9, 1.0, v9
    v_cvt_pk_bf16_f32 v10, v8, v9
    v_lshlrev_b32 v8, 16, v10
    v_and_b32 v9, 0xffff0000, v10
    v_lshlrev_b32 v10, 16, v19
    v_and_b32 v11, 0xffff0000, v19
    v_mul_f32 v8, v8, v10
    v_mul_f32 v9, v9, v11
    v_cvt_pk_bf16_f32 v10, v8, v9
    v_lshlrev_b32 v8, 16, v10
    v_and_b32 v9, 0xffff0000, v10
    v_lshlrev_b32 v10, 16, v27
    v_and_b32 v11, 0xffff0000, v27
    v_add_f32 v8, v8, v10
    v_add_f32 v9, v9, v11
    v_cvt_pk_bf16_f32 v27, v8, v9
    ds_write_b64 v13, v[24:25] offset:7168
    ds_write_b64 v13, v[26:27] offset:7296
    v_lshlrev_b32 v8, 16, v36
    v_and_b32 v9, 0xffff0000, v36
    v_add_f32 v8, 1.0, v8
    v_add_f32 v9, 1.0, v9
    v_cvt_pk_bf16_f32 v10, v8, v9
    v_lshlrev_b32 v8, 16, v10
    v_and_b32 v9, 0xffff0000, v10
    v_lshlrev_b32 v10, 16, v20
    v_and_b32 v11, 0xffff0000, v20
    v_mul_f32 v8, v8, v10
    v_mul_f32 v9, v9, v11
    v_cvt_pk_bf16_f32 v10, v8, v9
    v_lshlrev_b32 v8, 16, v10
    v_and_b32 v9, 0xffff0000, v10
    v_lshlrev_b32 v10, 16, v32
    v_and_b32 v11, 0xffff0000, v32
    v_add_f32 v8, v8, v10
    v_add_f32 v9, v9, v11
    v_cvt_pk_bf16_f32 v32, v8, v9
    v_lshlrev_b32 v8, 16, v37
    v_and_b32 v9, 0xffff0000, v37
    v_add_f32 v8, 1.0, v8
    v_add_f32 v9, 1.0, v9
    v_cvt_pk_bf16_f32 v10, v8, v9
    v_lshlrev_b32 v8, 16, v10
    v_and_b32 v9, 0xffff0000, v10
    v_lshlrev_b32 v10, 16, v21
    v_and_b32 v11, 0xffff0000, v21
    v_mul_f32 v8, v8, v10
    v_mul_f32 v9, v9, v11
    v_cvt_pk_bf16_f32 v10, v8, v9
    v_lshlrev_b32 v8, 16, v10
    v_and_b32 v9, 0xffff0000, v10
    v_lshlrev_b32 v10, 16, v33
    v_and_b32 v11, 0xffff0000, v33
    v_add_f32 v8, v8, v10
    v_add_f32 v9, v9, v11
    v_cvt_pk_bf16_f32 v33, v8, v9
    v_lshlrev_b32 v8, 16, v38
    v_and_b32 v9, 0xffff0000, v38
    v_add_f32 v8, 1.0, v8
    v_add_f32 v9, 1.0, v9
    v_cvt_pk_bf16_f32 v10, v8, v9
    v_lshlrev_b32 v8, 16, v10
    v_and_b32 v9, 0xffff0000, v10
    v_lshlrev_b32 v10, 16, v22
    v_and_b32 v11, 0xffff0000, v22
    v_mul_f32 v8, v8, v10
    v_mul_f32 v9, v9, v11
    v_cvt_pk_bf16_f32 v10, v8, v9
    v_lshlrev_b32 v8, 16, v10
    v_and_b32 v9, 0xffff0000, v10
    v_lshlrev_b32 v10, 16, v34
    v_and_b32 v11, 0xffff0000, v34
    v_add_f32 v8, v8, v10
    v_add_f32 v9, v9, v11
    v_cvt_pk_bf16_f32 v34, v8, v9
    v_lshlrev_b32 v8, 16, v39
    v_and_b32 v9, 0xffff0000, v39
    v_add_f32 v8, 1.0, v8
    v_add_f32 v9, 1.0, v9
    v_cvt_pk_bf16_f32 v10, v8, v9
    v_lshlrev_b32 v8, 16, v10
    v_and_b32 v9, 0xffff0000, v10
    v_lshlrev_b32 v10, 16, v23
    v_and_b32 v11, 0xffff0000, v23
    v_mul_f32 v8, v8, v10
    v_mul_f32 v9, v9, v11
    v_cvt_pk_bf16_f32 v10, v8, v9
    v_lshlrev_b32 v8, 16, v10
    v_and_b32 v9, 0xffff0000, v10
    v_lshlrev_b32 v10, 16, v35
    v_and_b32 v11, 0xffff0000, v35
    v_add_f32 v8, v8, v10
    v_add_f32 v9, v9, v11
    v_cvt_pk_bf16_f32 v35, v8, v9
    ds_write_b64 v13, v[32:33] offset:7184
    ds_write_b64 v13, v[34:35] offset:7312
    s_mov_b64 exec, -1
    s_cmp_lg_u32 s3, 8
    s_cbranch_scc1 L_SGBD
L_SGB:
    s_load_dword s42, s[28:29], 8 glc
    s_waitcnt lgkmcnt(0)
    s_cmp_lg_u32 s42, 0
    s_cbranch_scc1 L_SGBD
    s_sleep 6
    s_add_u32 s40, s40, 1
    s_cmp_lt_u32 s40, 400000
    s_cbranch_scc1 L_SGB
L_SGBD:
    s_waitcnt lgkmcnt(0)
    s_cmp_lt_u32 s36, 14
    s_cbranch_scc1 L_HM
    s_barrier
    s_barrier
L_HM:
    s_barrier
    s_cmp_ge_u32 s36, 28
    s_cbranch_scc1 L_FIN
    v_lshrrev_b32 v8, 1, v6
    v_and_b32 v8, 3, v8
    v_xor_b32 v8, s46, v8
    v_lshlrev_b32 v8, 5, v8
    v_lshl_add_u32 v8, v6, 7, v8
    v_and_b32 v9, 3, v0
    v_lshl_add_u32 v8, v9, 3, v8
    v_add_u32 v10, 85776, v8
    ds_read_b64_tr_b16 v[48:49], v10 offset:0
    ds_read_b64_tr_b16 v[50:51], v10 offset:2048
    ds_read_b64_tr_b16 v[52:53], v10 offset:4096
    ds_read_b64_tr_b16 v[54:55], v10 offset:6144
    ds_read_b64_tr_b16 v[56:57], v10 offset:8192
    ds_read_b64_tr_b16 v[58:59], v10 offset:10240
    ds_read_b64_tr_b16 v[60:61], v10 offset:12288
    ds_read_b64_tr_b16 v[62:63], v10 offset:14336
    ds_read_b64_tr_b16 v[64:65], v10 offset:16384
    ds_read_b64_tr_b16 v[66:67], v10 offset:18432
    ds_read_b64_tr_b16 v[68:69], v10 offset:20480
    ds_read_b64_tr_b16 v[70:71], v10 offset:22528
    ds_read_b64_tr_b16 v[72:73], v10 offset:24576
    ds_read_b64_tr_b16 v[74:75], v10 offset:26624
    s_waitcnt lgkmcnt(0)
    ds_read_b64_tr_b16 v[76:77], v10 offset:28672
    ds_read_b64_tr_b16 v[78:79], v10 offset:30720
    ds_read_b64_tr_b16 v[80:81], v10 offset:32768
    ds_read_b64_tr_b16 v[82:83], v10 offset:34816
    ds_read_b64_tr_b16 v[84:85], v10 offset:36864
    ds_read_b64_tr_b16 v[86:87], v10 offset:38912
    ds_read_b64_tr_b16 v[88:89], v10 offset:40960
    ds_read_b64_tr_b16 v[90:91], v10 offset:43008
    ds_read_b64_tr_b16 v[92:93], v10 offset:45056
    ds_read_b64_tr_b16 v[94:95], v10 offset:47104
    ds_read_b64_tr_b16 v[96:97], v10 offset:49152
    ds_read_b64_tr_b16 v[98:99], v10 offset:51200
    ds_read_b64_tr_b16 v[100:101], v10 offset:53248
    ds_read_b64_tr_b16 v[102:103], v10 offset:55296
    s_waitcnt lgkmcnt(0)
    ds_read_b128 v[104:107], v14 offset:7168
    ds_read_b128 v[108:111], v14 offset:7680
    ds_read_b128 v[112:115], v14 offset:8192
    ds_read_b128 v[116:119], v14 offset:8704
    ds_read_b128 v[120:123], v14 offset:9216
    ds_read_b128 v[124:127], v14 offset:9728
    ds_read_b128 v[128:131], v14 offset:10240
    ds_read_b128 v[132:135], v14 offset:10752
    ds_read_b128 v[136:139], v14 offset:11264
    ds_read_b128 v[140:143], v14 offset:11776
    ds_read_b128 v[144:147], v14 offset:12288
    ds_read_b128 v[148:151], v14 offset:12800
    ds_read_b128 v[152:155], v14 offset:13312
    ds_read_b128 v[156:159], v14 offset:13824
    v_and_b32 v8, 7, v2
    v_mul_u32_u24 v8, 144, v8
    v_lshl_add_u32 v8, v1, 3, v8
    s_lshr_b32 s43, s3, 2
    s_mul_i32 s43, s43, 1152
    s_lshl_b32 s44, s46, 5
    s_add_u32 s43, s43, s44
    v_add_u32 v8, s43, v8
    s_waitcnt lgkmcnt(13)
    v_mfma_f32_16x16x32_bf16 v[160:163], v[48:51], v[104:107], 0
    s_waitcnt lgkmcnt(12)
    v_mfma_f32_16x16x32_bf16 v[160:163], v[52:55], v[108:111], v[160:163]
    s_waitcnt lgkmcnt(11)
    v_mfma_f32_16x16x32_bf16 v[160:163], v[56:59], v[112:115], v[160:163]
    s_waitcnt lgkmcnt(10)
    v_mfma_f32_16x16x32_bf16 v[160:163], v[60:63], v[116:119], v[160:163]
    s_waitcnt lgkmcnt(9)
    v_mfma_f32_16x16x32_bf16 v[160:163], v[64:67], v[120:123], v[160:163]
    s_waitcnt lgkmcnt(8)
    v_mfma_f32_16x16x32_bf16 v[160:163], v[68:71], v[124:127], v[160:163]
    s_waitcnt lgkmcnt(7)
    v_mfma_f32_16x16x32_bf16 v[160:163], v[72:75], v[128:131], v[160:163]
    s_waitcnt lgkmcnt(6)
    v_mfma_f32_16x16x32_bf16 v[160:163], v[76:79], v[132:135], v[160:163]
    s_waitcnt lgkmcnt(5)
    v_mfma_f32_16x16x32_bf16 v[160:163], v[80:83], v[136:139], v[160:163]
    s_waitcnt lgkmcnt(4)
    v_mfma_f32_16x16x32_bf16 v[160:163], v[84:87], v[140:143], v[160:163]
    s_waitcnt lgkmcnt(3)
    v_mfma_f32_16x16x32_bf16 v[160:163], v[88:91], v[144:147], v[160:163]
    s_waitcnt lgkmcnt(2)
    v_mfma_f32_16x16x32_bf16 v[160:163], v[92:95], v[148:151], v[160:163]
    s_waitcnt lgkmcnt(1)
    v_mfma_f32_16x16x32_bf16 v[160:163], v[96:99], v[152:155], v[160:163]
    s_waitcnt lgkmcnt(0)
    v_mfma_f32_16x16x32_bf16 v[160:163], v[100:103], v[156:159], v[160:163]
    s_nop 7
    v_cvt_pk_bf16_f32 v10, v160, v161
    v_cvt_pk_bf16_f32 v11, v162, v163
    v_min_u32 v10, -2, v10
    v_min_u32 v11, -2, v11
    ds_write_b64 v8, v[10:11] offset:16640
    s_waitcnt lgkmcnt(0)
    s_barrier
    s_cmp_lg_u32 s3, 8
    s_cbranch_scc1 L_FIN
    s_sub_u32 s42, s67, 256
    s_cmp_lt_u32 s36, 14
    s_cselect_b32 s42, s42, s66
    s_add_u32 s42, s42, 65536
    v_lshrrev_b32 v12, 3, v0
    v_mul_u32_u24 v13, 144, v12
    v_and_b32 v9, 7, v0
    v_lshl_add_u32 v13, v9, 4, v13
    s_lshr_b32 s43, s3, 2
    s_mul_i32 s44, s43, 1152
    v_add_u32 v13, s44, v13
    v_lshlrev_b32 v12, 13, v12
    v_lshl_add_u32 v12, v9, 4, v12
    ds_read_b128 v[8:11], v13 offset:16640
    s_lshl_b32 s43, s43, 7
    s_add_u32 s43, s43, s42
    s_waitcnt lgkmcnt(0)
    buffer_store_dwordx4 v[8:11], v12, s[32:35], s43 offen sc1
    s_barrier
    s_branch L_FIN
L_C8:
    s_mov_b32 s48, s22
    s_and_b32 s49, s23, 0xffff
    s_mov_b32 s50, 7168
    s_mov_b32 s51, 0x20000
    s_lshl_b32 s42, s3, 10
    buffer_load_dwordx4 v[16:19], v15, s[48:51], s42 offen
    s_mov_b32 s56, s10
    s_and_b32 s57, s11, 0xffff
    s_mov_b32 s58, 3670016
    s_mov_b32 s59, 0x20000
    s_mov_b32 s48, s24
    s_and_b32 s49, s25, 0xffff
    s_mov_b32 s50, 2408448
    s_mov_b32 s51, 0x20000
    s_cmp_ge_u32 s36, 14
    s_cbranch_scc1 L_R1Q
    v_lshrrev_b32 v8, 3, v0
    v_mul_u32_u24 v8, 5376, v8
    v_add_u32 v8, v8, v5
    s_mul_i32 s43, s3, 301056
    s_add_u32 s43, s43, s67
    s_mul_i32 s44, s3, 7168
    s_add_u32 s44, s44, 85776
    s_mov_b32 m0, s44
    s_nop 0
    buffer_load_dwordx4 v8, s[48:51], s43 offen nt lds
    s_add_u32 s43, s43, 43008
    s_add_u32 s44, s44, 1024
    s_mov_b32 m0, s44
    s_nop 0
    buffer_load_dwordx4 v8, s[48:51], s43 offen nt lds
    s_add_u32 s43, s43, 43008
    s_add_u32 s44, s44, 1024
    s_mov_b32 m0, s44
    s_nop 0
    buffer_load_dwordx4 v8, s[48:51], s43 offen nt lds
    s_add_u32 s43, s43, 43008
    s_add_u32 s44, s44, 1024
    s_mov_b32 m0, s44
    s_nop 0
    buffer_load_dwordx4 v8, s[48:51], s43 offen nt lds
    s_add_u32 s43, s43, 43008
    s_add_u32 s44, s44, 1024
    s_mov_b32 m0, s44
    s_nop 0
    buffer_load_dwordx4 v8, s[48:51], s43 offen nt lds
    s_add_u32 s43, s43, 43008
    s_add_u32 s44, s44, 1024
    s_mov_b32 m0, s44
    s_nop 0
    buffer_load_dwordx4 v8, s[48:51], s43 offen nt lds
    s_add_u32 s43, s43, 43008
    s_add_u32 s44, s44, 1024
    s_mov_b32 m0, s44
    s_nop 0
    buffer_load_dwordx4 v8, s[48:51], s43 offen nt lds
    s_branch L_R1D
L_R1Q:
    v_lshrrev_b32 v8, 3, v0
    v_lshlrev_b32 v8, 13, v8
    v_add_u32 v8, v8, v5
    v_add_u32 v9, 128, v8
    s_mul_i32 s43, s3, 458752
    s_add_u32 s43, s43, s66
    s_mul_i32 s44, s3, 7168
    s_add_u32 s42, s44, 20224
    s_add_u32 s44, s44, 85776
    s_mov_b32 m0, s44
    s_nop 0
    buffer_load_dwordx4 v8, s[56:59], s43 offen nt lds
    s_mov_b32 m0, s42
    s_nop 0
    buffer_load_dwordx4 v9, s[56:59], s43 offen nt lds
    s_cmp_ge_u32 s36, 28
    s_cbranch_scc1 LT3_3
    buffer_load_dwordx4 v[104:107], v8, s[56:59], s43 offen offset:256 nt
LT3_3:
    s_add_u32 s43, s43, 65536
    s_add_u32 s44, s44, 1024
    s_add_u32 s42, s42, 1024
    s_mov_b32 m0, s44
    s_nop 0
    buffer_load_dwordx4 v8, s[56:59], s43 offen nt lds
    s_mov_b32 m0, s42
    s_nop 0
    buffer_load_dwordx4 v9, s[56:59], s43 offen nt lds
    s_cmp_ge_u32 s36, 28
    s_cbranch_scc1 LT3_4
    buffer_load_dwordx4 v[108:111], v8, s[56:59], s43 offen offset:256 nt
LT3_4:
    s_add_u32 s43, s43, 65536
    s_add_u32 s44, s44, 1024
    s_add_u32 s42, s42, 1024
    s_mov_b32 m0, s44
    s_nop 0
    buffer_load_dwordx4 v8, s[56:59], s43 offen nt lds
    s_mov_b32 m0, s42
    s_nop 0
    buffer_load_dwordx4 v9, s[56:59], s43 offen nt lds
    s_cmp_ge_u32 s36, 28
    s_cbranch_scc1 LT3_5
    buffer_load_dwordx4 v[112:115], v8, s[56:59], s43 offen offset:256 nt
LT3_5:
    s_add_u32 s43, s43, 65536
    s_add_u32 s44, s44, 1024
    s_add_u32 s42, s42, 1024
    s_mov_b32 m0, s44
    s_nop 0
    buffer_load_dwordx4 v8, s[56:59], s43 offen nt lds
    s_mov_b32 m0, s42
    s_nop 0
    buffer_load_dwordx4 v9, s[56:59], s43 offen nt lds
    s_cmp_ge_u32 s36, 28
    s_cbranch_scc1 LT3_6
    buffer_load_dwordx4 v[116:119], v8, s[56:59], s43 offen offset:256 nt
LT3_6:
    s_add_u32 s43, s43, 65536
    s_add_u32 s44, s44, 1024
    s_add_u32 s42, s42, 1024
    s_mov_b32 m0, s44
    s_nop 0
    buffer_load_dwordx4 v8, s[56:59], s43 offen nt lds
    s_mov_b32 m0, s42
    s_nop 0
    buffer_load_dwordx4 v9, s[56:59], s43 offen nt lds
    s_cmp_ge_u32 s36, 28
    s_cbranch_scc1 LT3_7
    buffer_load_dwordx4 v[120:123], v8, s[56:59], s43 offen offset:256 nt
LT3_7:
    s_add_u32 s43, s43, 65536
    s_add_u32 s44, s44, 1024
    s_add_u32 s42, s42, 1024
    s_mov_b32 m0, s44
    s_nop 0
    buffer_load_dwordx4 v8, s[56:59], s43 offen nt lds
    s_mov_b32 m0, s42
    s_nop 0
    buffer_load_dwordx4 v9, s[56:59], s43 offen nt lds
    s_cmp_ge_u32 s36, 28
    s_cbranch_scc1 LT3_8
    buffer_load_dwordx4 v[124:127], v8, s[56:59], s43 offen offset:256 nt
LT3_8:
    s_add_u32 s43, s43, 65536
    s_add_u32 s44, s44, 1024
    s_add_u32 s42, s42, 1024
    s_mov_b32 m0, s44
    s_nop 0
    buffer_load_dwordx4 v8, s[56:59], s43 offen nt lds
    s_mov_b32 m0, s42
    s_nop 0
    buffer_load_dwordx4 v9, s[56:59], s43 offen nt lds
    s_cmp_ge_u32 s36, 28
    s_cbranch_scc1 LT3_9
    buffer_load_dwordx4 v[128:131], v8, s[56:59], s43 offen offset:256 nt
LT3_9:
L_R1D:
    s_waitcnt vmcnt(7)
    s_cmp_eq_u32 s3, 7
    s_cbranch_scc1 L_NOSILU
    s_mov_b32 s44, 0xbfb8aa3b
    v_lshlrev_b32 v8, 16, v16
    v_and_b32 v9, 0xffff0000, v16
    v_mul_f32 v10, s44, abs(v8)
    v_mul_f32 v11, s44, abs(v9)
    v_exp_f32 v10, v10
    v_exp_f32 v11, v11
    v_add_f32 v12, 1.0, v10
    v_add_f32 v13, 1.0, v11
    v_rcp_f32 v12, v12
    v_rcp_f32 v13, v13
    v_mul_f32 v10, v10, v12
    v_mul_f32 v11, v11, v13
    v_max_f32 v12, 0, v8
    v_max_f32 v13, 0, v9
    v_fma_f32 v8, -abs(v8), v10, v12
    v_fma_f32 v9, -abs(v9), v11, v13
    v_cvt_pk_bf16_f32 v16, v8, v9
    v_lshlrev_b32 v8, 16, v17
    v_and_b32 v9, 0xffff0000, v17
    v_mul_f32 v10, s44, abs(v8)
    v_mul_f32 v11, s44, abs(v9)
    v_exp_f32 v10, v10
    v_exp_f32 v11, v11
    v_add_f32 v12, 1.0, v10
    v_add_f32 v13, 1.0, v11
    v_rcp_f32 v12, v12
    v_rcp_f32 v13, v13
    v_mul_f32 v10, v10, v12
    v_mul_f32 v11, v11, v13
    v_max_f32 v12, 0, v8
    v_max_f32 v13, 0, v9
    v_fma_f32 v8, -abs(v8), v10, v12
    v_fma_f32 v9, -abs(v9), v11, v13
    v_cvt_pk_bf16_f32 v17, v8, v9
    v_lshlrev_b32 v8, 16, v18
    v_and_b32 v9, 0xffff0000, v18
    v_mul_f32 v10, s44, abs(v8)
    v_mul_f32 v11, s44, abs(v9)
    v_exp_f32 v10, v10
    v_exp_f32 v11, v11
    v_add_f32 v12, 1.0, v10
    v_add_f32 v13, 1.0, v11
    v_rcp_f32 v12, v12
    v_rcp_f32 v13, v13
    v_mul_f32 v10, v10, v12
    v_mul_f32 v11, v11, v13
    v_max_f32 v12, 0, v8
    v_max_f32 v13, 0, v9
    v_fma_f32 v8, -abs(v8), v10, v12
    v_fma_f32 v9, -abs(v9), v11, v13
    v_cvt_pk_bf16_f32 v18, v8, v9
    v_lshlrev_b32 v8, 16, v19
    v_and_b32 v9, 0xffff0000, v19
    v_mul_f32 v10, s44, abs(v8)
    v_mul_f32 v11, s44, abs(v9)
    v_exp_f32 v10, v10
    v_exp_f32 v11, v11
    v_add_f32 v12, 1.0, v10
    v_add_f32 v13, 1.0, v11
    v_rcp_f32 v12, v12
    v_rcp_f32 v13, v13
    v_mul_f32 v10, v10, v12
    v_mul_f32 v11, v11, v13
    v_max_f32 v12, 0, v8
    v_max_f32 v13, 0, v9
    v_fma_f32 v8, -abs(v8), v10, v12
    v_fma_f32 v9, -abs(v9), v11, v13
    v_cvt_pk_bf16_f32 v19, v8, v9
    s_lshl_b32 s42, s3, 6
    v_add_u32 v8, s42, v0
    v_mul_u32_u24 v9, 1171, v8
    v_lshrrev_b32 v9, 16, v9
    v_mul_u32_u24 v10, 56, v9
    v_sub_u32 v10, v8, v10
    v_lshrrev_b32 v11, 2, v10
    v_lshlrev_b32 v11, 9, v11
    v_lshl_add_u32 v11, v9, 4, v11
    v_and_b32 v12, 1, v10
    v_lshl_add_u32 v11, v12, 8, v11
    v_bfe_u32 v12, v10, 1, 1
    v_lshl_add_u32 v11, v12, 3, v11
    ds_write_b64 v11, v[16:17] offset:0
    ds_write_b64 v11, v[18:19] offset:128
L_NOSILU:
    s_waitcnt vmcnt(0) lgkmcnt(0)
    s_barrier
    s_cmp_ge_u32 s36, 14
    s_cbranch_scc1 L_CQ
    s_cmp_ge_u32 s3, 4
    s_cbranch_scc1 L_U1
    s_mov_b32 s42, 20224
    s_cmp_lt_u32 s3, 4
    s_cselect_b32 s42, 85776, s42
    v_lshrrev_b32 v8, 1, v6
    v_and_b32 v8, 3, v8
    v_xor_b32 v8, s46, v8
    v_lshlrev_b32 v8, 5, v8
    v_lshl_add_u32 v8, v6, 7, v8
    v_and_b32 v9, 3, v0
    v_lshl_add_u32 v8, v9, 3, v8
    v_add_u32 v10, s42, v8
    ds_read_b64_tr_b16 v[48:49], v10 offset:0
    ds_read_b64_tr_b16 v[50:51], v10 offset:2048
    ds_read_b64_tr_b16 v[52:53], v10 offset:4096
    ds_read_b64_tr_b16 v[54:55], v10 offset:6144
    ds_read_b64_tr_b16 v[56:57], v10 offset:8192
    ds_read_b64_tr_b16 v[58:59], v10 offset:10240
    ds_read_b64_tr_b16 v[60:61], v10 offset:12288
    ds_read_b64_tr_b16 v[62:63], v10 offset:14336
    ds_read_b64_tr_b16 v[64:65], v10 offset:16384
    ds_read_b64_tr_b16 v[66:67], v10 offset:18432
    ds_read_b64_tr_b16 v[68:69], v10 offset:20480
    ds_read_b64_tr_b16 v[70:71], v10 offset:22528
    ds_read_b64_tr_b16 v[72:73], v10 offset:24576
    ds_read_b64_tr_b16 v[74:75], v10 offset:26624
    s_waitcnt lgkmcnt(0)
    ds_read_b64_tr_b16 v[76:77], v10 offset:28672
    ds_read_b64_tr_b16 v[78:79], v10 offset:30720
    ds_read_b64_tr_b16 v[80:81], v10 offset:32768
    ds_read_b64_tr_b16 v[82:83], v10 offset:34816
    ds_read_b64_tr_b16 v[84:85], v10 offset:36864
    ds_read_b64_tr_b16 v[86:87], v10 offset:38912
    ds_read_b64_tr_b16 v[88:89], v10 offset:40960
    ds_read_b64_tr_b16 v[90:91], v10 offset:43008
    ds_read_b64_tr_b16 v[92:93], v10 offset:45056
    ds_read_b64_tr_b16 v[94:95], v10 offset:47104
    ds_read_b64_tr_b16 v[96:97], v10 offset:49152
    ds_read_b64_tr_b16 v[98:99], v10 offset:51200
    ds_read_b64_tr_b16 v[100:101], v10 offset:53248
    ds_read_b64_tr_b16 v[102:103], v10 offset:55296
    s_waitcnt lgkmcnt(0)
    ds_read_b128 v[104:107], v14 offset:0
    ds_read_b128 v[108:111], v14 offset:512
    ds_read_b128 v[112:115], v14 offset:1024
    ds_read_b128 v[116:119], v14 offset:1536
    ds_read_b128 v[120:123], v14 offset:2048
    ds_read_b128 v[124:127], v14 offset:2560
    ds_read_b128 v[128:131], v14 offset:3072
    ds_read_b128 v[132:135], v14 offset:3584
    ds_read_b128 v[136:139], v14 offset:4096
    ds_read_b128 v[140:143], v14 offset:4608
    ds_read_b128 v[144:147], v14 offset:5120
    ds_read_b128 v[148:151], v14 offset:5632
    ds_read_b128 v[152:155], v14 offset:6144
    ds_read_b128 v[156:159], v14 offset:6656
    v_and_b32 v8, 7, v2
    v_mul_u32_u24 v8, 144, v8
    v_lshl_add_u32 v8, v1, 3, v8
    s_lshr_b32 s43, s3, 2
    s_mul_i32 s43, s43, 1152
    s_lshl_b32 s44, s46, 5
    s_add_u32 s43, s43, s44
    v_add_u32 v8, s43, v8
    s_waitcnt lgkmcnt(13)
    v_mfma_f32_16x16x32_bf16 v[160:163], v[48:51], v[104:107], 0
    s_waitcnt lgkmcnt(12)
    v_mfma_f32_16x16x32_bf16 v[160:163], v[52:55], v[108:111], v[160:163]
    s_waitcnt lgkmcnt(11)
    v_mfma_f32_16x16x32_bf16 v[160:163], v[56:59], v[112:115], v[160:163]
    s_waitcnt lgkmcnt(10)
    v_mfma_f32_16x16x32_bf16 v[160:163], v[60:63], v[116:119], v[160:163]
    s_waitcnt lgkmcnt(9)
    v_mfma_f32_16x16x32_bf16 v[160:163], v[64:67], v[120:123], v[160:163]
    s_waitcnt lgkmcnt(8)
    v_mfma_f32_16x16x32_bf16 v[160:163], v[68:71], v[124:127], v[160:163]
    s_waitcnt lgkmcnt(7)
    v_mfma_f32_16x16x32_bf16 v[160:163], v[72:75], v[128:131], v[160:163]
    s_waitcnt lgkmcnt(6)
    v_mfma_f32_16x16x32_bf16 v[160:163], v[76:79], v[132:135], v[160:163]
    s_waitcnt lgkmcnt(5)
    v_mfma_f32_16x16x32_bf16 v[160:163], v[80:83], v[136:139], v[160:163]
    s_waitcnt lgkmcnt(4)
    v_mfma_f32_16x16x32_bf16 v[160:163], v[84:87], v[140:143], v[160:163]
    s_waitcnt lgkmcnt(3)
    v_mfma_f32_16x16x32_bf16 v[160:163], v[88:91], v[144:147], v[160:163]
    s_waitcnt lgkmcnt(2)
    v_mfma_f32_16x16x32_bf16 v[160:163], v[92:95], v[148:151], v[160:163]
    s_waitcnt lgkmcnt(1)
    v_mfma_f32_16x16x32_bf16 v[160:163], v[96:99], v[152:155], v[160:163]
    s_waitcnt lgkmcnt(0)
    v_mfma_f32_16x16x32_bf16 v[160:163], v[100:103], v[156:159], v[160:163]
    s_nop 7
    v_cvt_pk_bf16_f32 v10, v160, v161
    v_cvt_pk_bf16_f32 v11, v162, v163
    v_min_u32 v10, -2, v10
    v_min_u32 v11, -2, v11
    ds_write_b64 v8, v[10:11] offset:16640
    s_waitcnt lgkmcnt(0)
L_U1:
    s_barrier
    s_cmp_lg_u32 s3, 0
    s_cbranch_scc1 L_U2
    s_add_u32 s42, s67, 0
    v_lshrrev_b32 v12, 3, v0
    v_mul_u32_u24 v13, 144, v12
    v_and_b32 v9, 7, v0
    v_lshl_add_u32 v13, v9, 4, v13
    s_lshr_b32 s43, s3, 2
    s_mul_i32 s44, s43, 1152
    v_add_u32 v13, s44, v13
    v_lshlrev_b32 v12, 11, v12
    v_lshl_add_u32 v12, v9, 4, v12
    ds_read_b128 v[8:11], v13 offset:16640
    s_lshl_b32 s43, s43, 7
    s_add_u32 s43, s43, s42
    s_waitcnt lgkmcnt(0)
    buffer_store_dwordx4 v[8:11], v12, s[32:35], s43 offen sc1
L_U2:
    s_barrier
    s_nop 0
    v_lshrrev_b32 v8, 3, v0
    v_mul_u32_u24 v8, 8192, v8
    v_add_u32 v8, v8, v5
    s_mul_i32 s43, s3, 458752
    s_add_u32 s43, s43, s67
    s_mul_i32 s44, s3, 7168
    s_add_u32 s44, s44, 85776
    s_mov_b32 m0, s44
    s_nop 0
    buffer_load_dwordx4 v8, s[56:59], s43 offen nt lds
    s_add_u32 s43, s43, 65536
    s_add_u32 s44, s44, 1024
    s_mov_b32 m0, s44
    s_nop 0
    buffer_load_dwordx4 v8, s[56:59], s43 offen nt lds
    s_add_u32 s43, s43, 65536
    s_add_u32 s44, s44, 1024
    s_mov_b32 m0, s44
    s_nop 0
    buffer_load_dwordx4 v8, s[56:59], s43 offen nt lds
    s_add_u32 s43, s43, 65536
    s_add_u32 s44, s44, 1024
    s_mov_b32 m0, s44
    s_nop 0
    buffer_load_dwordx4 v8, s[56:59], s43 offen nt lds
    s_add_u32 s43, s43, 65536
    s_add_u32 s44, s44, 1024
    s_mov_b32 m0, s44
    s_nop 0
    buffer_load_dwordx4 v8, s[56:59], s43 offen nt lds
    s_add_u32 s43, s43, 65536
    s_add_u32 s44, s44, 1024
    s_mov_b32 m0, s44
    s_nop 0
    buffer_load_dwordx4 v8, s[56:59], s43 offen nt lds
    s_add_u32 s43, s43, 65536
    s_add_u32 s44, s44, 1024
    s_mov_b32 m0, s44
    s_nop 0
    buffer_load_dwordx4 v8, s[56:59], s43 offen nt lds
    s_waitcnt vmcnt(0)
    s_barrier
    s_barrier
    s_branch L_CLZ
L_CQ:
    s_mov_b32 s42, 20224
    s_cmp_lt_u32 s3, 4
    s_cselect_b32 s42, 85776, s42
    v_lshrrev_b32 v8, 1, v6
    v_and_b32 v8, 3, v8
    v_xor_b32 v8, s46, v8
    v_lshlrev_b32 v8, 5, v8
    v_lshl_add_u32 v8, v6, 7, v8
    v_and_b32 v9, 3, v0
    v_lshl_add_u32 v8, v9, 3, v8
    v_add_u32 v10, s42, v8
    ds_read_b64_tr_b16 v[48:49], v10 offset:0
    ds_read_b64_tr_b16 v[50:51], v10 offset:2048
    ds_read_b64_tr_b16 v[52:53], v10 offset:4096
    ds_read_b64_tr_b16 v[54:55], v10 offset:6144
    ds_read_b64_tr_b16 v[56:57], v10 offset:8192
    ds_read_b64_tr_b16 v[58:59], v10 offset:10240
    ds_read_b64_tr_b16 v[60:61], v10 offset:12288
    ds_read_b64_tr_b16 v[62:63], v10 offset:14336
    ds_read_b64_tr_b16 v[64:65], v10 offset:16384
    ds_read_b64_tr_b16 v[66:67], v10 offset:18432
    ds_read_b64_tr_b16 v[68:69], v10 offset:20480
    ds_read_b64_tr_b16 v[70:71], v10 offset:22528
    ds_read_b64_tr_b16 v[72:73], v10 offset:24576
    ds_read_b64_tr_b16 v[74:75], v10 offset:26624
    s_waitcnt lgkmcnt(0)
    ds_read_b64_tr_b16 v[76:77], v10 offset:28672
    ds_read_b64_tr_b16 v[78:79], v10 offset:30720
    ds_read_b64_tr_b16 v[80:81], v10 offset:32768
    ds_read_b64_tr_b16 v[82:83], v10 offset:34816
    ds_read_b64_tr_b16 v[84:85], v10 offset:36864
    ds_read_b64_tr_b16 v[86:87], v10 offset:38912
    ds_read_b64_tr_b16 v[88:89], v10 offset:40960
    ds_read_b64_tr_b16 v[90:91], v10 offset:43008
    ds_read_b64_tr_b16 v[92:93], v10 offset:45056
    ds_read_b64_tr_b16 v[94:95], v10 offset:47104
    ds_read_b64_tr_b16 v[96:97], v10 offset:49152
    ds_read_b64_tr_b16 v[98:99], v10 offset:51200
    ds_read_b64_tr_b16 v[100:101], v10 offset:53248
    ds_read_b64_tr_b16 v[102:103], v10 offset:55296
    s_waitcnt lgkmcnt(0)
    s_barrier
    s_mul_i32 s43, s3, 7168
    s_add_u32 s43, s43, 85776
    v_add_u32 v8, s43, v15
    ds_write_b128 v8, v[104:107] offset:0
    ds_write_b128 v8, v[108:111] offset:1024
    ds_write_b128 v8, v[112:115] offset:2048
    ds_write_b128 v8, v[116:119] offset:3072
    ds_write_b128 v8, v[120:123] offset:4096
    ds_write_b128 v8, v[124:127] offset:5120
    ds_write_b128 v8, v[128:131] offset:6144
    s_waitcnt lgkmcnt(0)
    s_barrier
    ds_read_b128 v[104:107], v14 offset:7168
    ds_read_b128 v[108:111], v14 offset:7680
    ds_read_b128 v[112:115], v14 offset:8192
    ds_read_b128 v[116:119], v14 offset:8704
    ds_read_b128 v[120:123], v14 offset:9216
    ds_read_b128 v[124:127], v14 offset:9728
    ds_read_b128 v[128:131], v14 offset:10240
    ds_read_b128 v[132:135], v14 offset:10752
    ds_read_b128 v[136:139], v14 offset:11264
    ds_read_b128 v[140:143], v14 offset:11776
    ds_read_b128 v[144:147], v14 offset:12288
    ds_read_b128 v[148:151], v14 offset:12800
    ds_read_b128 v[152:155], v14 offset:13312
    ds_read_b128 v[156:159], v14 offset:13824
    v_and_b32 v8, 7, v2
    v_mul_u32_u24 v8, 144, v8
    v_lshl_add_u32 v8, v1, 3, v8
    s_lshr_b32 s43, s3, 2
    s_mul_i32 s43, s43, 1152
    s_lshl_b32 s44, s46, 5
    s_add_u32 s43, s43, s44
    v_add_u32 v8, s43, v8
    s_waitcnt lgkmcnt(13)
    v_mfma_f32_16x16x32_bf16 v[160:163], v[48:51], v[104:107], 0
    s_waitcnt lgkmcnt(12)
    v_mfma_f32_16x16x32_bf16 v[160:163], v[52:55], v[108:111], v[160:163]
    s_waitcnt lgkmcnt(11)
    v_mfma_f32_16x16x32_bf16 v[160:163], v[56:59], v[112:115], v[160:163]
    s_waitcnt lgkmcnt(10)
    v_mfma_f32_16x16x32_bf16 v[160:163], v[60:63], v[116:119], v[160:163]
    s_waitcnt lgkmcnt(9)
    v_mfma_f32_16x16x32_bf16 v[160:163], v[64:67], v[120:123], v[160:163]
    s_waitcnt lgkmcnt(8)
    v_mfma_f32_16x16x32_bf16 v[160:163], v[68:71], v[124:127], v[160:163]
    s_waitcnt lgkmcnt(7)
    v_mfma_f32_16x16x32_bf16 v[160:163], v[72:75], v[128:131], v[160:163]
    s_waitcnt lgkmcnt(6)
    v_mfma_f32_16x16x32_bf16 v[160:163], v[76:79], v[132:135], v[160:163]
    s_waitcnt lgkmcnt(5)
    v_mfma_f32_16x16x32_bf16 v[160:163], v[80:83], v[136:139], v[160:163]
    s_waitcnt lgkmcnt(4)
    v_mfma_f32_16x16x32_bf16 v[160:163], v[84:87], v[140:143], v[160:163]
    s_waitcnt lgkmcnt(3)
    v_mfma_f32_16x16x32_bf16 v[160:163], v[88:91], v[144:147], v[160:163]
    s_waitcnt lgkmcnt(2)
    v_mfma_f32_16x16x32_bf16 v[160:163], v[92:95], v[148:151], v[160:163]
    s_waitcnt lgkmcnt(1)
    v_mfma_f32_16x16x32_bf16 v[160:163], v[96:99], v[152:155], v[160:163]
    s_waitcnt lgkmcnt(0)
    v_mfma_f32_16x16x32_bf16 v[160:163], v[100:103], v[156:159], v[160:163]
    s_nop 7
    v_cvt_pk_bf16_f32 v10, v160, v161
    v_cvt_pk_bf16_f32 v11, v162, v163
    v_min_u32 v10, -2, v10
    v_min_u32 v11, -2, v11
    ds_write_b64 v8, v[10:11] offset:16640
    s_waitcnt lgkmcnt(0)
    s_barrier
    s_cmp_lg_u32 s46, 0
    s_cbranch_scc1 L_CQ2
    s_add_u32 s42, s66, 65536
    v_lshrrev_b32 v12, 3, v0
    v_mul_u32_u24 v13, 144, v12
    v_and_b32 v9, 7, v0
    v_lshl_add_u32 v13, v9, 4, v13
    s_lshr_b32 s43, s3, 2
    s_mul_i32 s44, s43, 1152
    v_add_u32 v13, s44, v13
    v_lshlrev_b32 v12, 13, v12
    v_lshl_add_u32 v12, v9, 4, v12
    ds_read_b128 v[8:11], v13 offset:16640
    s_lshl_b32 s43, s43, 7
    s_add_u32 s43, s43, s42
    s_waitcnt lgkmcnt(0)
    buffer_store_dwordx4 v[8:11], v12, s[32:35], s43 offen sc1
L_CQ2:
    s_cmp_ge_u32 s36, 28
    s_cbranch_scc1 L_FIN
L_CLZ:
    s_barrier
    s_add_u32 s42, s67, 1792
    v_lshrrev_b32 v8, 3, v0
    v_mul_u32_u24 v8, 5376, v8
    v_add_u32 v8, v8, v5
    s_mul_i32 s43, s3, 301056
    s_add_u32 s43, s43, s42
    s_mul_i32 s44, s3, 7168
    s_add_u32 s44, s44, 20224
    s_mov_b32 m0, s44
    s_nop 0
    buffer_load_dwordx4 v8, s[48:51], s43 offen nt lds
    s_add_u32 s43, s43, 43008
    s_add_u32 s44, s44, 1024
    s_mov_b32 m0, s44
    s_nop 0
    buffer_load_dwordx4 v8, s[48:51], s43 offen nt lds
    s_add_u32 s43, s43, 43008
    s_add_u32 s44, s44, 1024
    s_mov_b32 m0, s44
    s_nop 0
    buffer_load_dwordx4 v8, s[48:51], s43 offen nt lds
    s_add_u32 s43, s43, 43008
    s_add_u32 s44, s44, 1024
    s_mov_b32 m0, s44
    s_nop 0
    buffer_load_dwordx4 v8, s[48:51], s43 offen nt lds
    s_add_u32 s43, s43, 43008
    s_add_u32 s44, s44, 1024
    s_mov_b32 m0, s44
    s_nop 0
    buffer_load_dwordx4 v8, s[48:51], s43 offen nt lds
    s_add_u32 s43, s43, 43008
    s_add_u32 s44, s44, 1024
    s_mov_b32 m0, s44
    s_nop 0
    buffer_load_dwordx4 v8, s[48:51], s43 offen nt lds
    s_add_u32 s43, s43, 43008
    s_add_u32 s44, s44, 1024
    s_mov_b32 m0, s44
    s_nop 0
    buffer_load_dwordx4 v8, s[48:51], s43 offen nt lds
    s_waitcnt vmcnt(0)
    s_barrier
    s_cmp_lt_u32 s3, 4
    s_cbranch_scc1 L_FIN
    s_mov_b32 s42, 20224
    s_cmp_lt_u32 s3, 4
    s_cselect_b32 s42, 85776, s42
    v_lshrrev_b32 v8, 1, v6
    v_and_b32 v8, 3, v8
    v_xor_b32 v8, s46, v8
    v_lshlrev_b32 v8, 5, v8
    v_lshl_add_u32 v8, v6, 7, v8
    v_and_b32 v9, 3, v0
    v_lshl_add_u32 v8, v9, 3, v8
    v_add_u32 v10, s42, v8
    ds_read_b64_tr_b16 v[48:49], v10 offset:0
    ds_read_b64_tr_b16 v[50:51], v10 offset:2048
    ds_read_b64_tr_b16 v[52:53], v10 offset:4096
    ds_read_b64_tr_b16 v[54:55], v10 offset:6144
    ds_read_b64_tr_b16 v[56:57], v10 offset:8192
    ds_read_b64_tr_b16 v[58:59], v10 offset:10240
    ds_read_b64_tr_b16 v[60:61], v10 offset:12288
    ds_read_b64_tr_b16 v[62:63], v10 offset:14336
    ds_read_b64_tr_b16 v[64:65], v10 offset:16384
    ds_read_b64_tr_b16 v[66:67], v10 offset:18432
    ds_read_b64_tr_b16 v[68:69], v10 offset:20480
    ds_read_b64_tr_b16 v[70:71], v10 offset:22528
    ds_read_b64_tr_b16 v[72:73], v10 offset:24576
    ds_read_b64_tr_b16 v[74:75], v10 offset:26624
    s_waitcnt lgkmcnt(0)
    ds_read_b64_tr_b16 v[76:77], v10 offset:28672
    ds_read_b64_tr_b16 v[78:79], v10 offset:30720
    ds_read_b64_tr_b16 v[80:81], v10 offset:32768
    ds_read_b64_tr_b16 v[82:83], v10 offset:34816
    ds_read_b64_tr_b16 v[84:85], v10 offset:36864
    ds_read_b64_tr_b16 v[86:87], v10 offset:38912
    ds_read_b64_tr_b16 v[88:89], v10 offset:40960
    ds_read_b64_tr_b16 v[90:91], v10 offset:43008
    ds_read_b64_tr_b16 v[92:93], v10 offset:45056
    ds_read_b64_tr_b16 v[94:95], v10 offset:47104
    ds_read_b64_tr_b16 v[96:97], v10 offset:49152
    ds_read_b64_tr_b16 v[98:99], v10 offset:51200
    ds_read_b64_tr_b16 v[100:101], v10 offset:53248
    ds_read_b64_tr_b16 v[102:103], v10 offset:55296
    s_waitcnt lgkmcnt(0)
    ds_read_b128 v[104:107], v14 offset:0
    ds_read_b128 v[108:111], v14 offset:512
    ds_read_b128 v[112:115], v14 offset:1024
    ds_read_b128 v[116:119], v14 offset:1536
    ds_read_b128 v[120:123], v14 offset:2048
    ds_read_b128 v[124:127], v14 offset:2560
    ds_read_b128 v[128:131], v14 offset:3072
    ds_read_b128 v[132:135], v14 offset:3584
    ds_read_b128 v[136:139], v14 offset:4096
    ds_read_b128 v[140:143], v14 offset:4608
    ds_read_b128 v[144:147], v14 offset:5120
    ds_read_b128 v[148:151], v14 offset:5632
    ds_read_b128 v[152:155], v14 offset:6144
    ds_read_b128 v[156:159], v14 offset:6656
    v_and_b32 v8, 7, v2
    v_mul_u32_u24 v8, 144, v8
    v_lshl_add_u32 v8, v1, 3, v8
    s_lshr_b32 s43, s3, 2
    s_mul_i32 s43, s43, 1152
    s_lshl_b32 s44, s46, 5
    s_add_u32 s43, s43, s44
    v_add_u32 v8, s43, v8
    s_waitcnt lgkmcnt(13)
    v_mfma_f32_16x16x32_bf16 v[160:163], v[48:51], v[104:107], 0
    s_waitcnt lgkmcnt(12)
    v_mfma_f32_16x16x32_bf16 v[160:163], v[52:55], v[108:111], v[160:163]
    s_waitcnt lgkmcnt(11)
    v_mfma_f32_16x16x32_bf16 v[160:163], v[56:59], v[112:115], v[160:163]
    s_waitcnt lgkmcnt(10)
    v_mfma_f32_16x16x32_bf16 v[160:163], v[60:63], v[116:119], v[160:163]
    s_waitcnt lgkmcnt(9)
    v_mfma_f32_16x16x32_bf16 v[160:163], v[64:67], v[120:123], v[160:163]
    s_waitcnt lgkmcnt(8)
    v_mfma_f32_16x16x32_bf16 v[160:163], v[68:71], v[124:127], v[160:163]
    s_waitcnt lgkmcnt(7)
    v_mfma_f32_16x16x32_bf16 v[160:163], v[72:75], v[128:131], v[160:163]
    s_waitcnt lgkmcnt(6)
    v_mfma_f32_16x16x32_bf16 v[160:163], v[76:79], v[132:135], v[160:163]
    s_waitcnt lgkmcnt(5)
    v_mfma_f32_16x16x32_bf16 v[160:163], v[80:83], v[136:139], v[160:163]
    s_waitcnt lgkmcnt(4)
    v_mfma_f32_16x16x32_bf16 v[160:163], v[84:87], v[140:143], v[160:163]
    s_waitcnt lgkmcnt(3)
    v_mfma_f32_16x16x32_bf16 v[160:163], v[88:91], v[144:147], v[160:163]
    s_waitcnt lgkmcnt(2)
    v_mfma_f32_16x16x32_bf16 v[160:163], v[92:95], v[148:151], v[160:163]
    s_waitcnt lgkmcnt(1)
    v_mfma_f32_16x16x32_bf16 v[160:163], v[96:99], v[152:155], v[160:163]
    s_waitcnt lgkmcnt(0)
    v_mfma_f32_16x16x32_bf16 v[160:163], v[100:103], v[156:159], v[160:163]
    s_nop 7
    v_cvt_pk_bf16_f32 v10, v160, v161
    v_cvt_pk_bf16_f32 v11, v162, v163
    v_min_u32 v10, -2, v10
    v_min_u32 v11, -2, v11
    ds_write_b64 v8, v[10:11] offset:16640
    s_waitcnt lgkmcnt(0)
    s_barrier
    s_cmp_lg_u32 s3, 4
    s_cbranch_scc1 L_FIN
    s_add_u32 s42, s67, 16256
    v_lshrrev_b32 v12, 3, v0
    v_mul_u32_u24 v13, 144, v12
    v_and_b32 v9, 7, v0
    v_lshl_add_u32 v13, v9, 4, v13
    s_lshr_b32 s43, s3, 2
    s_mul_i32 s44, s43, 1152
    v_add_u32 v13, s44, v13
    v_lshlrev_b32 v12, 12, v12
    v_lshl_add_u32 v12, v9, 4, v12
    ds_read_b128 v[8:11], v13 offset:16640
    s_lshl_b32 s43, s43, 7
    s_add_u32 s43, s43, s42
    s_waitcnt lgkmcnt(0)
    buffer_store_dwordx4 v[8:11], v12, s[32:35], s43 offen sc1
    s_waitcnt vmcnt(0)
    s_mov_b32 s42, 1
    s_atomic_add s42, s[28:29], 144 glc
    s_waitcnt lgkmcnt(0)
    s_cmp_lg_u32 s42, 27
    s_cbranch_scc1 L_CG1
    s_mov_b64 exec, 1
    buffer_store_dword v4, v3, s[52:55], 0 offen offset:48 sc1
    s_mov_b64 exec, -1
L_CG1:
    s_branch L_FIN
L_TAILWG:
    s_waitcnt lgkmcnt(0)
    s_mov_b32 s32, s30
    s_and_b32 s33, s31, 0xffff
    s_mov_b32 s34, 536870912
    s_mov_b32 s35, 0x20000
    s_mov_b32 s52, s28
    s_and_b32 s53, s29, 0xffff
    s_mov_b32 s54, 256
    s_mov_b32 s55, 0x20000
    v_cmp_lt_u32 s[60:61], 7, v2
    v_lshlrev_b32 v15, 4, v0
    v_bfe_u32 v8, v0, 1, 2
    v_bfe_u32 v9, v0, 4, 2
    v_xor_b32 v8, v8, v9
    v_lshlrev_b32 v8, 5, v8
    v_and_b32 v9, 1, v0
    v_lshl_add_u32 v5, v9, 4, v8
    s_and_b32 s46, s3, 3
    s_mov_b32 s47, 0
    s_cmp_lt_u32 s3, 8
    s_cbranch_scc1 L_T8
    v_mov_b32 v8, -1
    v_mov_b32 v9, -1
    v_mov_b32 v10, -1
    v_mov_b32 v11, -1
    s_sub_u32 s46, s3, 8
    s_cmp_lg_u32 s3, 10
    s_cbranch_scc1 L_TC3
    s_setprio 3
    s_getreg_b32 s42, hwreg(HW_REG_XCC_ID, 0, 4)
    s_mul_i32 s43, s42, s42
    s_lshl_b32 s43, s43, 16
    s_lshl_b32 s42, s42, 6
    s_add_u32 s43, s43, s42
    s_add_u32 s43, s43, 1
    v_mov_b32 v12, s43
    s_mov_b64 exec, 1
    buffer_atomic_add v12, v3, s[52:55], 0 offen offset:148 sc0 sc1
    s_waitcnt vmcnt(0)
    v_readfirstlane_b32 s42, v12
    s_nop 0
    s_add_u32 s42, s42, s43
    s_and_b32 s43, s42, 63
    s_cmp_lg_u32 s43, 32
    s_cbranch_scc1 L_TC5
    s_bfe_u32 s43, s42, 0xa0006
    s_mul_i32 s43, s43, s43
    s_lshr_b32 s42, s42, 16
    s_lshl_b32 s42, s42, 5
    s_cmp_eq_u32 s42, s43
    s_cselect_b32 s42, 1, 2
    v_mov_b32 v12, s42
    buffer_store_dword v12, v3, s[52:55], 0 offen offset:12 sc1
L_TC5:
    s_mov_b64 exec, -1
    s_setprio 0
L_TC3:
    s_cmp_lg_u32 s36, 31
    s_cbranch_scc1 L_T9
    s_getpc_b64 s[64:65]
L_PCT:
    s_sub_u32 s64, s64, L_PCT-adaLN_cond__sliding_block_cached__glu_gated_swiglu__decode_kernel
    s_subb_u32 s65, s65, 0
    v_lshlrev_b32 v12, 7, v0
    s_lshl_b32 s41, s46, 13
    v_add_u32 v12, s41, v12
    v_cmp_gt_u32 vcc, L_CODE_END-adaLN_cond__sliding_block_cached__glu_gated_swiglu__decode_kernel, v12
    s_nop 0
    s_and_b64 exec, exec, vcc
    s_cbranch_execz L_NOPFT
    global_load_dword v13, v12, s[64:65]
L_NOPFT:
    s_mov_b64 exec, -1
    s_branch L_T9
L_T8:
    s_mov_b32 s56, s12
    s_and_b32 s57, s13, 0xffff
    s_mov_b32 s58, 3670016
    s_mov_b32 s59, 0x20000
    v_lshrrev_b32 v8, 3, v0
    v_mul_u32_u24 v8, 896, v8
    v_add_u32 v8, v8, v5
    v_add_u32 v9, 128, v8
    s_lshr_b32 s42, s36, 2
    s_lshl_b32 s42, s42, 9
    s_lshl_b32 s43, s3, 5
    s_add_u32 s42, s42, s43
    s_mul_i32 s42, s42, 896
    s_and_b32 s41, s36, 3
    s_lshl_b32 s43, s41, 8
    s_add_u32 s43, s43, s42
    s_lshl_b32 s44, s3, 12
    s_add_u32 s44, s44, 85776
    s_cmp_lg_u32 s41, 3
    s_cbranch_scc1 L_WX
    v_mov_b32 v9, v8
L_WX:
    s_mov_b32 m0, s44
    s_nop 0
    buffer_load_dwordx4 v8, s[56:59], s43 offen nt lds
    s_add_u32 s42, s44, 32768
    s_mov_b32 m0, s42
    s_nop 0
    buffer_load_dwordx4 v9, s[56:59], s43 offen nt lds
    s_add_u32 s43, s43, 7168
    s_add_u32 s44, s44, 1024
    s_mov_b32 m0, s44
    s_nop 0
    buffer_load_dwordx4 v8, s[56:59], s43 offen nt lds
    s_add_u32 s42, s44, 32768
    s_mov_b32 m0, s42
    s_nop 0
    buffer_load_dwordx4 v9, s[56:59], s43 offen nt lds
    s_add_u32 s43, s43, 7168
    s_add_u32 s44, s44, 1024
    s_mov_b32 m0, s44
    s_nop 0
    buffer_load_dwordx4 v8, s[56:59], s43 offen nt lds
    s_add_u32 s42, s44, 32768
    s_mov_b32 m0, s42
    s_nop 0
    buffer_load_dwordx4 v9, s[56:59], s43 offen nt lds
    s_add_u32 s43, s43, 7168
    s_add_u32 s44, s44, 1024
    s_mov_b32 m0, s44
    s_nop 0
    buffer_load_dwordx4 v8, s[56:59], s43 offen nt lds
    s_add_u32 s42, s44, 32768
    s_mov_b32 m0, s42
    s_nop 0
    buffer_load_dwordx4 v9, s[56:59], s43 offen nt lds
    s_add_u32 s43, s43, 207872
    s_sub_u32 s44, s44, 68624
    s_mov_b32 m0, s44
    s_nop 0
    buffer_load_dwordx4 v8, s[56:59], s43 offen nt lds
    s_add_u32 s42, s44, 32768
    s_mov_b32 m0, s42
    s_nop 0
    buffer_load_dwordx4 v9, s[56:59], s43 offen nt lds
    s_add_u32 s43, s43, 7168
    s_add_u32 s44, s44, 1024
    s_mov_b32 m0, s44
    s_nop 0
    buffer_load_dwordx4 v8, s[56:59], s43 offen nt lds
    s_add_u32 s42, s44, 32768
    s_mov_b32 m0, s42
    s_nop 0
    buffer_load_dwordx4 v9, s[56:59], s43 offen nt lds
    s_add_u32 s43, s43, 7168
    s_add_u32 s44, s44, 1024
    s_mov_b32 m0, s44
    s_nop 0
    buffer_load_dwordx4 v8, s[56:59], s43 offen nt lds
    s_add_u32 s42, s44, 32768
    s_mov_b32 m0, s42
    s_nop 0
    buffer_load_dwordx4 v9, s[56:59], s43 offen nt lds
    s_add_u32 s43, s43, 7168
    s_add_u32 s44, s44, 1024
    s_mov_b32 m0, s44
    s_nop 0
    buffer_load_dwordx4 v8, s[56:59], s43 offen nt lds
    s_add_u32 s42, s44, 32768
    s_mov_b32 m0, s42
    s_nop 0
    buffer_load_dwordx4 v9, s[56:59], s43 offen nt lds
L_T9:
    v_bfe_u32 v8, v0, 2, 2
    v_lshl_add_u32 v6, v1, 2, v8
    v_mul_u32_u24 v7, 928, v6
    v_and_b32 v8, 3, v0
    v_lshl_add_u32 v7, v8, 4, v7
    v_and_b32 v14, 7, v2
    v_lshlrev_b32 v14, 4, v14
    v_lshl_add_u32 v14, v1, 7, v14
    s_waitcnt vmcnt(8)
    s_barrier
    s_cmp_ge_u32 s3, 8
    s_cbranch_scc1 LFW_10
    s_lshr_b32 s43, s3, 2
    s_lshl_b32 s43, s43, 15
    s_add_u32 s43, s43, 85776
    v_lshrrev_b32 v8, 1, v6
    v_and_b32 v8, 3, v8
    v_xor_b32 v8, s46, v8
    v_lshlrev_b32 v8, 5, v8
    v_lshl_add_u32 v8, v6, 7, v8
    v_and_b32 v9, 3, v0
    v_lshl_add_u32 v8, v9, 3, v8
    v_add_u32 v10, s43, v8
    ds_read_b64_tr_b16 v[16:17], v10 offset:0
    ds_read_b64_tr_b16 v[18:19], v10 offset:2048
    ds_read_b64_tr_b16 v[20:21], v10 offset:4096
    ds_read_b64_tr_b16 v[22:23], v10 offset:6144
    ds_read_b64_tr_b16 v[24:25], v10 offset:8192
    ds_read_b64_tr_b16 v[26:27], v10 offset:10240
    ds_read_b64_tr_b16 v[28:29], v10 offset:12288
    ds_read_b64_tr_b16 v[30:31], v10 offset:14336
    s_waitcnt lgkmcnt(0)
    ds_read_b64_tr_b16 v[32:33], v10 offset:16384
    ds_read_b64_tr_b16 v[34:35], v10 offset:18432
    ds_read_b64_tr_b16 v[36:37], v10 offset:20480
    ds_read_b64_tr_b16 v[38:39], v10 offset:22528
    ds_read_b64_tr_b16 v[40:41], v10 offset:24576
    ds_read_b64_tr_b16 v[42:43], v10 offset:26624
    ds_read_b64_tr_b16 v[44:45], v10 offset:28672
    ds_read_b64_tr_b16 v[46:47], v10 offset:30720
    s_waitcnt lgkmcnt(0)
LFW_10:
    s_barrier
    s_cmp_ge_u32 s3, 8
    s_cbranch_scc1 LL_11
    s_cmp_ge_u32 s36, 28
    s_cbranch_scc1 LL_11
    s_mov_b32 s48, s20
    s_and_b32 s49, s21, 0xffff
    s_mov_b32 s50, 1605632
    s_mov_b32 s51, 0x20000
    s_lshl_b32 s42, s36, 6
    s_lshl_b32 s43, s3, 3
    s_mul_i32 s44, s43, 928
    s_add_u32 s44, s44, 85776
    s_add_u32 s43, s43, s42
    s_mul_i32 s43, s43, 896
    s_mov_b32 exec_hi, 0x00ffffff
    s_mov_b32 m0, s44
    s_nop 0
    buffer_load_dwordx4 v15, s[48:51], s43 offen nt lds
    s_add_u32 s43, s43, 896
    s_add_u32 s44, s44, 928
    s_mov_b32 m0, s44
    s_nop 0
    buffer_load_dwordx4 v15, s[48:51], s43 offen nt lds
    s_add_u32 s43, s43, 896
    s_add_u32 s44, s44, 928
    s_mov_b32 m0, s44
    s_nop 0
    buffer_load_dwordx4 v15, s[48:51], s43 offen nt lds
    s_add_u32 s43, s43, 896
    s_add_u32 s44, s44, 928
    s_mov_b32 m0, s44
    s_nop 0
    buffer_load_dwordx4 v15, s[48:51], s43 offen nt lds
    s_add_u32 s43, s43, 896
    s_add_u32 s44, s44, 928
    s_mov_b32 m0, s44
    s_nop 0
    buffer_load_dwordx4 v15, s[48:51], s43 offen nt lds
    s_add_u32 s43, s43, 896
    s_add_u32 s44, s44, 928
    s_mov_b32 m0, s44
    s_nop 0
    buffer_load_dwordx4 v15, s[48:51], s43 offen nt lds
    s_add_u32 s43, s43, 896
    s_add_u32 s44, s44, 928
    s_mov_b32 m0, s44
    s_nop 0
    buffer_load_dwordx4 v15, s[48:51], s43 offen nt lds
    s_add_u32 s43, s43, 896
    s_add_u32 s44, s44, 928
    s_mov_b32 m0, s44
    s_nop 0
    buffer_load_dwordx4 v15, s[48:51], s43 offen nt lds
    s_mov_b64 exec, -1
    s_waitcnt vmcnt(8)
    s_branch L_T10
LL_11:
    s_waitcnt vmcnt(0)
L_T10:
    s_barrier
    s_cmp_ge_u32 s3, 8
    s_cbranch_scc1 LFW_12
    s_lshr_b32 s43, s3, 2
    s_lshl_b32 s43, s43, 15
    s_add_u32 s43, s43, 20224
    v_lshrrev_b32 v8, 1, v6
    v_and_b32 v8, 3, v8
    v_xor_b32 v8, s46, v8
    v_lshlrev_b32 v8, 5, v8
    v_lshl_add_u32 v8, v6, 7, v8
    v_and_b32 v9, 3, v0
    v_lshl_add_u32 v8, v9, 3, v8
    v_add_u32 v10, s43, v8
    ds_read_b64_tr_b16 v[48:49], v10 offset:0
    ds_read_b64_tr_b16 v[50:51], v10 offset:2048
    ds_read_b64_tr_b16 v[52:53], v10 offset:4096
    ds_read_b64_tr_b16 v[54:55], v10 offset:6144
    ds_read_b64_tr_b16 v[56:57], v10 offset:8192
    ds_read_b64_tr_b16 v[58:59], v10 offset:10240
    ds_read_b64_tr_b16 v[60:61], v10 offset:12288
    ds_read_b64_tr_b16 v[62:63], v10 offset:14336
    s_waitcnt lgkmcnt(0)
    ds_read_b64_tr_b16 v[64:65], v10 offset:16384
    ds_read_b64_tr_b16 v[66:67], v10 offset:18432
    ds_read_b64_tr_b16 v[68:69], v10 offset:20480
    ds_read_b64_tr_b16 v[70:71], v10 offset:22528
    ds_read_b64_tr_b16 v[72:73], v10 offset:24576
    ds_read_b64_tr_b16 v[74:75], v10 offset:26624
    ds_read_b64_tr_b16 v[76:77], v10 offset:28672
    ds_read_b64_tr_b16 v[78:79], v10 offset:30720
    s_waitcnt lgkmcnt(0)
LFW_12:
    s_barrier
    s_cmp_ge_u32 s3, 8
    s_cbranch_scc1 LL_13
    s_cmp_ge_u32 s36, 28
    s_cbranch_scc1 LL_13
    s_mov_b32 s48, s16
    s_and_b32 s49, s17, 0xffff
    s_mov_b32 s50, 1605632
    s_mov_b32 s51, 0x20000
    s_lshl_b32 s42, s36, 7
    v_lshrrev_b32 v8, 3, v0
    v_mul_u32_u24 v8, 3584, v8
    v_add_u32 v8, v8, v5
    s_mul_i32 s43, s3, 200704
    s_add_u32 s43, s43, s42
    s_mul_i32 s44, s3, 7168
    s_add_u32 s44, s44, 20224
    s_mov_b32 m0, s44
    s_nop 0
    buffer_load_dwordx4 v8, s[48:51], s43 offen nt lds
    s_add_u32 s43, s43, 28672
    s_add_u32 s44, s44, 1024
    s_mov_b32 m0, s44
    s_nop 0
    buffer_load_dwordx4 v8, s[48:51], s43 offen nt lds
    s_add_u32 s43, s43, 28672
    s_add_u32 s44, s44, 1024
    s_mov_b32 m0, s44
    s_nop 0
    buffer_load_dwordx4 v8, s[48:51], s43 offen nt lds
    s_add_u32 s43, s43, 28672
    s_add_u32 s44, s44, 1024
    s_mov_b32 m0, s44
    s_nop 0
    buffer_load_dwordx4 v8, s[48:51], s43 offen nt lds
    s_add_u32 s43, s43, 28672
    s_add_u32 s44, s44, 1024
    s_mov_b32 m0, s44
    s_nop 0
    buffer_load_dwordx4 v8, s[48:51], s43 offen nt lds
    s_add_u32 s43, s43, 28672
    s_add_u32 s44, s44, 1024
    s_mov_b32 m0, s44
    s_nop 0
    buffer_load_dwordx4 v8, s[48:51], s43 offen nt lds
    s_add_u32 s43, s43, 28672
    s_add_u32 s44, s44, 1024
    s_mov_b32 m0, s44
    s_nop 0
    buffer_load_dwordx4 v8, s[48:51], s43 offen nt lds
    s_waitcnt vmcnt(7)
    s_branch L_T14
LL_13:
    s_cmp_lt_u32 s3, 8
    s_cbranch_scc1 L_T11
    s_cmp_eq_u32 s3, 11
    s_cbranch_scc1 L_T11
    s_mov_b64 exec, 1
L_PM:
    buffer_load_dword v9, v3, s[52:55], 0 offen offset:12 sc1
    s_waitcnt vmcnt(0)
    v_cmp_eq_u32 vcc, 0, v9
    s_cbranch_vccz L_PMD
    s_sleep 4
    s_add_u32 s40, s40, 1
    s_cmp_lt_u32 s40, 400000
    s_cbranch_scc1 L_PM
L_PMD:
    s_mov_b64 exec, -1
    v_readfirstlane_b32 s47, v9
    s_cmp_ge_u32 s36, 28
    s_cbranch_scc1 L_T11
    v_mov_b32 v8, -1
    v_mov_b32 v9, -1
    v_mov_b32 v10, -1
    v_mov_b32 v11, -1
    s_cmp_eq_u32 s3, 10
    s_cbranch_scc1 L_T12
    s_mul_i32 s41, s36, 4352
    s_add_u32 s41, s41, 655360
    s_add_u32 s42, s41, 8192
    s_cmp_eq_u32 s3, 8
    s_cbranch_scc1 L_T13
    s_mul_i32 s41, s36, 8448
    s_add_u32 s41, s41, 786432
    s_add_u32 s42, s41, 12288
L_T13:
    s_cmp_eq_u32 s47, 1
    s_cbranch_scc0 LS_14
    buffer_store_dwordx4 v[8:11], v15, s[32:35], s41 offen offset:0
    buffer_store_dwordx4 v[8:11], v15, s[32:35], s41 offen offset:1024
    buffer_store_dwordx4 v[8:11], v15, s[32:35], s41 offen offset:2048
    buffer_store_dwordx4 v[8:11], v15, s[32:35], s41 offen offset:3072
LS_15:
    s_add_u32 s41, s41, 4096
    s_cmp_lt_u32 s41, s42
    s_cbranch_scc1 L_T13
    s_branch L_T11
L_T12:
    s_cmp_ge_u32 s36, 8
    s_cbranch_scc1 L_T11
    s_lshl_b32 s41, s36, 10
    s_add_u32 s41, s41, 57344
    s_cmp_eq_u32 s47, 1
    s_cbranch_scc0 LS_16
    buffer_store_dwordx4 v[8:11], v15, s[32:35], s41 offen
LS_17:
L_T11:
    s_waitcnt vmcnt(0)
L_T14:
    s_barrier
    s_cmp_lg_u32 s3, 8
    s_cbranch_scc1 L_T15
    s_mov_b32 s42, 1
    s_atomic_add s42, s[28:29], 152 glc
    s_waitcnt lgkmcnt(0)
    s_cmp_lg_u32 s42, 31
    s_cbranch_scc1 L_CG2
    s_mov_b64 exec, 1
    buffer_store_dword v4, v3, s[52:55], 0 offen offset:4 sc1
    s_mov_b64 exec, -1
L_CG2:
L_T15:
    s_cmp_ge_u32 s36, 28
    s_cbranch_scc1 L_T16
    s_cmp_ge_u32 s3, 7
    s_cbranch_scc1 LFR_18
    s_lshl_b32 s43, s3, 7
    s_add_u32 s43, s43, 85776
    v_add_u32 v8, s43, v7
    ds_read_b64_tr_b16 v[80:81], v8 offset:0
    ds_read_b64_tr_b16 v[82:83], v8 offset:14848
    ds_read_b64_tr_b16 v[84:85], v8 offset:8
    ds_read_b64_tr_b16 v[86:87], v8 offset:14856
    ds_read_b64_tr_b16 v[88:89], v8 offset:64
    ds_read_b64_tr_b16 v[90:91], v8 offset:14912
    ds_read_b64_tr_b16 v[92:93], v8 offset:72
    ds_read_b64_tr_b16 v[94:95], v8 offset:14920
    s_waitcnt lgkmcnt(0)
    ds_read_b64_tr_b16 v[96:97], v8 offset:29696
    ds_read_b64_tr_b16 v[98:99], v8 offset:44544
    ds_read_b64_tr_b16 v[100:101], v8 offset:29704
    ds_read_b64_tr_b16 v[102:103], v8 offset:44552
    ds_read_b64_tr_b16 v[104:105], v8 offset:29760
    ds_read_b64_tr_b16 v[106:107], v8 offset:44608
    ds_read_b64_tr_b16 v[108:109], v8 offset:29768
    ds_read_b64_tr_b16 v[110:111], v8 offset:44616
    s_waitcnt lgkmcnt(0)
LFR_18:
L_T16:
    s_barrier
    s_cmp_ge_u32 s3, 8
    s_cbranch_scc1 LL_19
    s_cmp_ge_u32 s36, 28
    s_cbranch_scc1 LL_19
    s_mov_b32 s48, s18
    s_and_b32 s49, s19, 0xffff
    s_mov_b32 s50, 1605632
    s_mov_b32 s51, 0x20000
    s_lshl_b32 s42, s36, 7
    v_lshrrev_b32 v8, 3, v0
    v_mul_u32_u24 v8, 3584, v8
    v_add_u32 v8, v8, v5
    s_mul_i32 s43, s3, 200704
    s_add_u32 s43, s43, s42
    s_mul_i32 s44, s3, 7168
    s_add_u32 s44, s44, 85776
    s_mov_b32 m0, s44
    s_nop 0
    buffer_load_dwordx4 v8, s[48:51], s43 offen nt lds
    s_add_u32 s43, s43, 28672
    s_add_u32 s44, s44, 1024
    s_mov_b32 m0, s44
    s_nop 0
    buffer_load_dwordx4 v8, s[48:51], s43 offen nt lds
    s_add_u32 s43, s43, 28672
    s_add_u32 s44, s44, 1024
    s_mov_b32 m0, s44
    s_nop 0
    buffer_load_dwordx4 v8, s[48:51], s43 offen nt lds
    s_add_u32 s43, s43, 28672
    s_add_u32 s44, s44, 1024
    s_mov_b32 m0, s44
    s_nop 0
    buffer_load_dwordx4 v8, s[48:51], s43 offen nt lds
    s_add_u32 s43, s43, 28672
    s_add_u32 s44, s44, 1024
    s_mov_b32 m0, s44
    s_nop 0
    buffer_load_dwordx4 v8, s[48:51], s43 offen nt lds
    s_add_u32 s43, s43, 28672
    s_add_u32 s44, s44, 1024
    s_mov_b32 m0, s44
    s_nop 0
    buffer_load_dwordx4 v8, s[48:51], s43 offen nt lds
    s_add_u32 s43, s43, 28672
    s_add_u32 s44, s44, 1024
    s_mov_b32 m0, s44
    s_nop 0
    buffer_load_dwordx4 v8, s[48:51], s43 offen nt lds
LL_19:
    s_cmp_lg_u32 s3, 8
    s_cbranch_scc1 L_T17
    s_mov_b64 exec, 1
L_G1:
    buffer_load_dword v9, v3, s[52:55], 0 offen offset:4 sc1
    s_waitcnt vmcnt(0)
    v_cmp_eq_u32 vcc, 0, v9
    s_cbranch_vccz L_G1D
    s_sleep 8
    s_add_u32 s40, s40, 1
    s_cmp_lt_u32 s40, 400000
    s_cbranch_scc1 L_G1
L_G1D:
    s_mov_b64 exec, -1
    s_mov_b64 exec, 1
L_G1B:
    buffer_load_dword v9, v3, s[52:55], 0 offen offset:8 sc1
    s_waitcnt vmcnt(0)
    v_cmp_eq_u32 vcc, 0, v9
    s_cbranch_vccz L_G1BD
    s_sleep 8
    s_add_u32 s40, s40, 1
    s_cmp_lt_u32 s40, 400000
    s_cbranch_scc1 L_G1B
L_G1BD:
    s_mov_b64 exec, -1
    v_mov_b32 v9, s47
    ds_write_b32 v3, v9 offset:16640
L_T17:
    s_waitcnt vmcnt(0) lgkmcnt(0)
    s_barrier
    ds_read_b32 v9, v3 offset:16640
    s_waitcnt lgkmcnt(0)
    v_readfirstlane_b32 s47, v9
    s_mov_b32 s48, s4
    s_and_b32 s49, s5, 0xffff
    s_mov_b32 s50, 7168
    s_mov_b32 s51, 0x20000
    s_mov_b32 s56, s26
    s_and_b32 s57, s27, 0xffff
    s_mov_b32 s58, 7168
    s_mov_b32 s59, 0x20000
    v_lshlrev_b32 v13, 1, v0
    s_mov_b32 s66, 0
    s_mov_b32 s67, 0
    s_mov_b32 s45, 0
    v_mov_b32 v153, 0
    v_mov_b32 v12, 0
    s_cmp_ge_u32 s3, 8
    s_cbranch_scc1 L_T21
    v_lshrrev_b32 v8, 5, v0
    v_lshlrev_b32 v12, 3, v8
    v_lshlrev_b32 v8, 12, v8
    v_lshrrev_b32 v9, 2, v2
    v_lshl_add_u32 v8, v9, 9, v8
    v_and_b32 v9, 1, v2
    v_lshl_add_u32 v8, v9, 8, v8
    v_and_b32 v9, 1, v1
    v_lshl_add_u32 v8, v9, 7, v8
    v_bfe_u32 v9, v2, 1, 1
    v_lshl_add_u32 v8, v9, 3, v8
    s_lshl_b32 s42, s3, 4
    v_add_u32 v152, s42, v8
    v_lshrrev_b32 v8, 1, v1
    v_mul_u32_u24 v8, 2176, v8
    v_and_b32 v9, 1, v1
    v_lshl_add_u32 v8, v9, 10, v8
    v_lshl_add_u32 v153, v2, 4, v8
    s_lshr_b32 s39, s36, 2
    s_mul_i32 s41, s39, 24576
    s_mul_i32 s42, s3, 3072
    s_add_u32 s41, s41, s42
    s_add_u32 s41, s41, 131072
    s_lshl_b32 s42, s39, 9
    s_lshl_b32 s43, s3, 6
    s_add_u32 s42, s42, s43
    s_add_u32 s42, s42, 327680
    s_mov_b32 s69, 7
    s_and_b32 s66, s36, 3
    s_lshl_b32 s66, s66, 4
    s_lshl_b32 s43, s3, 1
    s_add_u32 s66, s66, s43
    s_mov_b32 s67, s66
    s_mul_i32 s66, s66, 2176
    s_lshl_b32 s43, s39, 7
    s_add_u32 s66, s66, s43
    s_add_u32 s66, s66, 655360
    s_branch L_AL0
L_T21:
    s_sub_u32 s43, s3, 8
    v_lshrrev_b32 v8, 1, v6
    v_and_b32 v8, 3, v8
    v_xor_b32 v8, s43, v8
    v_lshlrev_b32 v8, 5, v8
    v_lshl_add_u32 v8, v6, 7, v8
    v_and_b32 v9, 1, v0
    v_lshl_add_u32 v8, v9, 3, v8
    v_bfe_u32 v9, v0, 1, 1
    v_mul_u32_u24 v9, 65552, v9
    v_add_u32 v8, v8, v9
    v_add_u32 v10, 20224, v8
    v_add_u32 v11, 16, v10
    ds_read_b64_tr_b16 v[16:17], v10 offset:0
    ds_read_b64_tr_b16 v[18:19], v10 offset:2048
    ds_read_b64_tr_b16 v[20:21], v10 offset:4096
    ds_read_b64_tr_b16 v[22:23], v10 offset:6144
    ds_read_b64_tr_b16 v[24:25], v10 offset:8192
    ds_read_b64_tr_b16 v[26:27], v10 offset:10240
    ds_read_b64_tr_b16 v[28:29], v10 offset:12288
    ds_read_b64_tr_b16 v[30:31], v10 offset:14336
    ds_read_b64_tr_b16 v[32:33], v10 offset:16384
    ds_read_b64_tr_b16 v[34:35], v10 offset:18432
    ds_read_b64_tr_b16 v[36:37], v10 offset:20480
    ds_read_b64_tr_b16 v[38:39], v10 offset:22528
    ds_read_b64_tr_b16 v[40:41], v10 offset:24576
    ds_read_b64_tr_b16 v[42:43], v10 offset:26624
    s_waitcnt lgkmcnt(0)
    ds_read_b64_tr_b16 v[44:45], v10 offset:28672
    ds_read_b64_tr_b16 v[46:47], v10 offset:30720
    ds_read_b64_tr_b16 v[48:49], v10 offset:32768
    ds_read_b64_tr_b16 v[50:51], v10 offset:34816
    ds_read_b64_tr_b16 v[52:53], v10 offset:36864
    ds_read_b64_tr_b16 v[54:55], v10 offset:38912
    ds_read_b64_tr_b16 v[56:57], v10 offset:40960
    ds_read_b64_tr_b16 v[58:59], v10 offset:43008
    ds_read_b64_tr_b16 v[60:61], v10 offset:45056
    ds_read_b64_tr_b16 v[62:63], v10 offset:47104
    ds_read_b64_tr_b16 v[64:65], v10 offset:49152
    ds_read_b64_tr_b16 v[66:67], v10 offset:51200
    ds_read_b64_tr_b16 v[68:69], v10 offset:53248
    ds_read_b64_tr_b16 v[70:71], v10 offset:55296
    s_waitcnt lgkmcnt(0)
    ds_read_b64_tr_b16 v[72:73], v11 offset:0
    ds_read_b64_tr_b16 v[74:75], v11 offset:2048
    ds_read_b64_tr_b16 v[76:77], v11 offset:4096
    ds_read_b64_tr_b16 v[78:79], v11 offset:6144
    ds_read_b64_tr_b16 v[80:81], v11 offset:8192
    ds_read_b64_tr_b16 v[82:83], v11 offset:10240
    ds_read_b64_tr_b16 v[84:85], v11 offset:12288
    ds_read_b64_tr_b16 v[86:87], v11 offset:14336
    ds_read_b64_tr_b16 v[88:89], v11 offset:16384
    ds_read_b64_tr_b16 v[90:91], v11 offset:18432
    ds_read_b64_tr_b16 v[92:93], v11 offset:20480
    ds_read_b64_tr_b16 v[94:95], v11 offset:22528
    ds_read_b64_tr_b16 v[96:97], v11 offset:24576
    ds_read_b64_tr_b16 v[98:99], v11 offset:26624
    s_waitcnt lgkmcnt(0)
    ds_read_b64_tr_b16 v[100:101], v11 offset:28672
    ds_read_b64_tr_b16 v[102:103], v11 offset:30720
    ds_read_b64_tr_b16 v[104:105], v11 offset:32768
    ds_read_b64_tr_b16 v[106:107], v11 offset:34816
    ds_read_b64_tr_b16 v[108:109], v11 offset:36864
    ds_read_b64_tr_b16 v[110:111], v11 offset:38912
    ds_read_b64_tr_b16 v[112:113], v11 offset:40960
    ds_read_b64_tr_b16 v[114:115], v11 offset:43008
    ds_read_b64_tr_b16 v[116:117], v11 offset:45056
    ds_read_b64_tr_b16 v[118:119], v11 offset:47104
    ds_read_b64_tr_b16 v[120:121], v11 offset:49152
    ds_read_b64_tr_b16 v[122:123], v11 offset:51200
    ds_read_b64_tr_b16 v[124:125], v11 offset:53248
    ds_read_b64_tr_b16 v[126:127], v11 offset:55296
    s_waitcnt lgkmcnt(0)
    s_cmp_ge_u32 s36, 28
    s_cbranch_scc1 L_T22
    s_cmp_eq_u32 s3, 11
    s_cbranch_scc1 L_PAD0
    s_mul_i32 s41, s36, 8448
    s_add_u32 s41, s41, 786432
    s_mul_i32 s42, s36, 4352
    s_add_u32 s42, s42, 655360
    s_cmp_eq_u32 s3, 9
    s_cselect_b32 s41, s42, s41
    s_cmp_eq_u32 s3, 10
    s_cselect_b32 s41, 57344, s41
    v_lshlrev_b32 v8, 7, v0
    buffer_load_dword v128, v8, s[32:35], s41 offen sc1
    s_mov_b64 exec, 1
L_PGMM:
    buffer_load_dword v9, v3, s[52:55], 0 offen offset:48 sc1
    s_waitcnt vmcnt(0)
    v_cmp_eq_u32 vcc, 0, v9
    s_cbranch_vccz L_PGMMD
    s_sleep 8
    s_add_u32 s40, s40, 1
    s_cmp_lt_u32 s40, 400000
    s_cbranch_scc1 L_PGMM
L_PGMMD:
    s_mov_b64 exec, -1
    s_cmp_lg_u32 s3, 10
    s_cbranch_scc1 L_T23
    s_mov_b32 exec_hi, 0x00ffffff
    s_mov_b32 s41, 17280
    s_mov_b32 s42, 18176
    s_mov_b32 m0, 143120
    s_nop 0
    buffer_load_dwordx4 v15, s[32:35], s41 offen sc1 lds
    s_mov_b32 m0, 77568
    s_nop 0
    buffer_load_dwordx4 v15, s[32:35], s42 offen sc1 lds
    s_add_u32 s41, s41, 4096
    s_add_u32 s42, s42, 4096
    s_mov_b32 m0, 144016
    s_nop 0
    buffer_load_dwordx4 v15, s[32:35], s41 offen sc1 lds
    s_mov_b32 m0, 78464
    s_nop 0
    buffer_load_dwordx4 v15, s[32:35], s42 offen sc1 lds
    s_add_u32 s41, s41, 4096
    s_add_u32 s42, s42, 4096
    s_mov_b32 m0, 144912
    s_nop 0
    buffer_load_dwordx4 v15, s[32:35], s41 offen sc1 lds
    s_mov_b32 m0, 79360
    s_nop 0
    buffer_load_dwordx4 v15, s[32:35], s42 offen sc1 lds
    s_add_u32 s41, s41, 4096
    s_add_u32 s42, s42, 4096
    s_mov_b32 m0, 145808
    s_nop 0
    buffer_load_dwordx4 v15, s[32:35], s41 offen sc1 lds
    s_mov_b32 m0, 80256
    s_nop 0
    buffer_load_dwordx4 v15, s[32:35], s42 offen sc1 lds
    s_add_u32 s41, s41, 4096
    s_add_u32 s42, s42, 4096
    s_mov_b32 m0, 146704
    s_nop 0
    buffer_load_dwordx4 v15, s[32:35], s41 offen sc1 lds
    s_mov_b32 m0, 81152
    s_nop 0
    buffer_load_dwordx4 v15, s[32:35], s42 offen sc1 lds
    s_add_u32 s41, s41, 4096
    s_add_u32 s42, s42, 4096
    s_mov_b32 m0, 147600
    s_nop 0
    buffer_load_dwordx4 v15, s[32:35], s41 offen sc1 lds
    s_mov_b32 m0, 82048
    s_nop 0
    buffer_load_dwordx4 v15, s[32:35], s42 offen sc1 lds
    s_add_u32 s41, s41, 4096
    s_add_u32 s42, s42, 4096
    s_mov_b32 m0, 148496
    s_nop 0
    buffer_load_dwordx4 v15, s[32:35], s41 offen sc1 lds
    s_mov_b32 m0, 82944
    s_nop 0
    buffer_load_dwordx4 v15, s[32:35], s42 offen sc1 lds
    s_add_u32 s41, s41, 4096
    s_add_u32 s42, s42, 4096
    s_mov_b32 m0, 149392
    s_nop 0
    buffer_load_dwordx4 v15, s[32:35], s41 offen sc1 lds
    s_mov_b32 m0, 83840
    s_nop 0
    buffer_load_dwordx4 v15, s[32:35], s42 offen sc1 lds
    s_waitcnt vmcnt(0)
    s_mov_b64 exec, -1
    s_branch L_T22
L_T23:
    s_lshl_b32 s45, s36, 1
    s_add_u32 s45, s45, s3
    s_sub_u32 s45, s45, 8
    s_lshl_b32 s66, s45, 4
    s_add_u32 s42, s66, 16384
    s_add_u32 s67, s66, 57344
    v_and_b32 v8, 7, v0
    v_lshlrev_b32 v9, 2, v1
    v_lshl_add_u32 v10, v8, 12, v9
    v_lshl_add_u32 v12, v8, 10, v9
    v_mul_u32_u24 v13, 896, v8
    v_add_u32 v13, v13, v9
    buffer_load_dword v152, v10, s[32:35], s42 offen sc1
    buffer_load_dword v154, v10, s[32:35], s42 offen offset:2688 sc1
    buffer_load_dword v156, v13, s[48:51], s66 offen
    s_waitcnt vmcnt(0)
    v_and_b32 v153, 0xffff0000, v152
    v_lshlrev_b32 v152, 16, v152
    v_and_b32 v155, 0xffff0000, v154
    v_lshlrev_b32 v154, 16, v154
    v_and_b32 v157, 0xffff0000, v156
    v_lshlrev_b32 v156, 16, v156
L_T22:
    s_setprio 3
    s_branch L_TB1
.p2align 12
L_AL0:
L_AL:
    s_bitcmp1_b32 s69, 0
    s_cbranch_scc0 LA_20
    buffer_load_dwordx2 v[116:117], v12, s[32:35], s42 offen offset:0 sc1
    buffer_load_dwordx4 v[112:115], v15, s[32:35], s41 offen offset:0 sc1
LA_20:
    s_bitcmp1_b32 s69, 1
    s_cbranch_scc0 LA_21
    buffer_load_dwordx2 v[122:123], v12, s[32:35], s42 offen offset:16 sc1
    buffer_load_dwordx4 v[118:121], v15, s[32:35], s41 offen offset:1024 sc1
LA_21:
    s_bitcmp1_b32 s69, 2
    s_cbranch_scc0 LA_22
    buffer_load_dwordx2 v[128:129], v12, s[32:35], s42 offen offset:32 sc1
    buffer_load_dwordx4 v[124:127], v15, s[32:35], s41 offen offset:2048 sc1
LA_22:
    s_waitcnt vmcnt(0)
    s_bitcmp1_b32 s69, 0
    s_cbranch_scc0 LA_23
    v_max3_u32 v8, v112, v113, v114
    v_max3_u32 v8, v8, v115, v116
    v_max_u32 v8, v8, v117
    v_cmp_eq_u32 vcc, -1, v8
    s_cbranch_vccnz LA_23
    s_bitset0_b32 s69, 0
LA_23:
    s_bitcmp1_b32 s69, 1
    s_cbranch_scc0 LA_24
    v_max3_u32 v8, v118, v119, v120
    v_max3_u32 v8, v8, v121, v122
    v_max_u32 v8, v8, v123
    v_cmp_eq_u32 vcc, -1, v8
    s_cbranch_vccnz LA_24
    s_bitset0_b32 s69, 1
LA_24:
    s_bitcmp1_b32 s69, 2
    s_cbranch_scc0 LA_25
    v_max3_u32 v8, v124, v125, v126
    v_max3_u32 v8, v8, v127, v128
    v_max_u32 v8, v8, v129
    v_cmp_eq_u32 vcc, -1, v8
    s_cbranch_vccnz LA_25
    s_bitset0_b32 s69, 2
LA_25:
    s_cmp_eq_u32 s69, 0
    s_cbranch_scc1 L_ALD
    s_cmp_lg_u32 s69, 7
    s_cbranch_scc1 L_ALS
    s_sleep 8
L_ALS:
    s_add_u32 s40, s40, 1
    s_cmp_lt_u32 s40, 400000
    s_cbranch_scc1 L_AL
L_ALD:
    s_setprio 3
    v_max3_f32 v8, v116, v122, v128
    v_sub_f32 v116, v116, v8
    v_sub_f32 v122, v122, v8
    v_sub_f32 v128, v128, v8
    v_mul_f32 v116, s68, v116
    v_mul_f32 v122, s68, v122
    v_mul_f32 v128, s68, v128
    v_exp_f32 v116, v116
    v_exp_f32 v122, v122
    v_exp_f32 v128, v128
    v_lshlrev_b32 v132, 16, v112
    v_and_b32 v133, 0xffff0000, v112
    v_lshlrev_b32 v134, 16, v113
    v_and_b32 v135, 0xffff0000, v113
    v_lshlrev_b32 v136, 16, v114
    v_and_b32 v137, 0xffff0000, v114
    v_lshlrev_b32 v138, 16, v115
    v_and_b32 v139, 0xffff0000, v115
    v_mul_f32 v116, v116, v117
    v_mul_f32 v122, v122, v123
    v_mul_f32 v128, v128, v129
    v_add_f32 v8, v116, v122
    v_add_f32 v8, v8, v128
    v_rcp_f32 v8, v8
    v_lshlrev_b32 v140, 16, v118
    v_and_b32 v141, 0xffff0000, v118
    v_lshlrev_b32 v142, 16, v119
    v_and_b32 v143, 0xffff0000, v119
    v_lshlrev_b32 v144, 16, v120
    v_and_b32 v145, 0xffff0000, v120
    v_lshlrev_b32 v146, 16, v121
    v_and_b32 v147, 0xffff0000, v121
    v_mul_f32 v116, v116, v8
    v_mul_f32 v122, v122, v8
    v_mul_f32 v128, v128, v8
    v_mul_f32 v132, v132, v116
    v_mul_f32 v133, v133, v116
    v_mul_f32 v134, v134, v116
    v_mul_f32 v135, v135, v116
    v_mul_f32 v136, v136, v116
    v_mul_f32 v137, v137, v116
    v_mul_f32 v138, v138, v116
    v_mul_f32 v139, v139, v116
    v_fmac_f32 v132, v140, v122
    v_fmac_f32 v133, v141, v122
    v_fmac_f32 v134, v142, v122
    v_fmac_f32 v135, v143, v122
    v_fmac_f32 v136, v144, v122
    v_fmac_f32 v137, v145, v122
    v_fmac_f32 v138, v146, v122
    v_fmac_f32 v139, v147, v122
    v_lshlrev_b32 v140, 16, v124
    v_and_b32 v141, 0xffff0000, v124
    v_lshlrev_b32 v142, 16, v125
    v_and_b32 v143, 0xffff0000, v125
    v_lshlrev_b32 v144, 16, v126
    v_and_b32 v145, 0xffff0000, v126
    v_lshlrev_b32 v146, 16, v127
    v_and_b32 v147, 0xffff0000, v127
    v_fmac_f32 v132, v140, v128
    v_fmac_f32 v133, v141, v128
    v_fmac_f32 v134, v142, v128
    v_fmac_f32 v135, v143, v128
    v_fmac_f32 v136, v144, v128
    v_fmac_f32 v137, v145, v128
    v_fmac_f32 v138, v146, v128
    v_fmac_f32 v139, v147, v128
    v_cvt_pk_bf16_f32 v124, v132, v133
    v_cvt_pk_bf16_f32 v125, v134, v135
    v_cvt_pk_bf16_f32 v126, v136, v137
    v_cvt_pk_bf16_f32 v127, v138, v139
    ds_write_b64 v152, v[124:125] offset:7168
    ds_write_b64 v152, v[126:127] offset:9216
    s_waitcnt lgkmcnt(0)
L_TB1:
    s_barrier
    s_cmp_ge_u32 s3, 8
    s_cbranch_scc1 L_WOD
    s_cmp_ge_u32 s67, 56
    s_cbranch_scc1 L_WOD
    ds_read_b128 v[112:115], v14 offset:7168
    ds_read_b128 v[116:119], v14 offset:7680
    ds_read_b128 v[120:123], v14 offset:8192
    ds_read_b128 v[124:127], v14 offset:8704
    ds_read_b128 v[128:131], v14 offset:9216
    ds_read_b128 v[132:135], v14 offset:9728
    ds_read_b128 v[136:139], v14 offset:10240
    ds_read_b128 v[140:143], v14 offset:10752
    s_waitcnt lgkmcnt(7)
    v_mfma_f32_16x16x32_bf16 v[144:147], v[16:19], v[112:115], 0
    ds_read_b128 v[112:115], v14 offset:11264
    s_waitcnt lgkmcnt(7)
    v_mfma_f32_16x16x32_bf16 v[144:147], v[20:23], v[116:119], v[144:147]
    ds_read_b128 v[116:119], v14 offset:11776
    s_waitcnt lgkmcnt(7)
    v_mfma_f32_16x16x32_bf16 v[144:147], v[24:27], v[120:123], v[144:147]
    ds_read_b128 v[120:123], v14 offset:12288
    s_waitcnt lgkmcnt(7)
    v_mfma_f32_16x16x32_bf16 v[144:147], v[28:31], v[124:127], v[144:147]
    ds_read_b128 v[124:127], v14 offset:12800
    s_waitcnt lgkmcnt(7)
    v_mfma_f32_16x16x32_bf16 v[144:147], v[32:35], v[128:131], v[144:147]
    ds_read_b128 v[128:131], v14 offset:13312
    s_waitcnt lgkmcnt(7)
    v_mfma_f32_16x16x32_bf16 v[144:147], v[36:39], v[132:135], v[144:147]
    ds_read_b128 v[132:135], v14 offset:13824
    s_waitcnt lgkmcnt(7)
    v_mfma_f32_16x16x32_bf16 v[144:147], v[40:43], v[136:139], v[144:147]
    ds_read_b128 v[136:139], v14 offset:14336
    s_waitcnt lgkmcnt(7)
    v_mfma_f32_16x16x32_bf16 v[144:147], v[44:47], v[140:143], v[144:147]
    ds_read_b128 v[140:143], v14 offset:14848
    s_waitcnt lgkmcnt(7)
    v_mfma_f32_16x16x32_bf16 v[144:147], v[48:51], v[112:115], v[144:147]
    s_waitcnt lgkmcnt(6)
    v_mfma_f32_16x16x32_bf16 v[144:147], v[52:55], v[116:119], v[144:147]
    s_waitcnt lgkmcnt(5)
    v_mfma_f32_16x16x32_bf16 v[144:147], v[56:59], v[120:123], v[144:147]
    s_waitcnt lgkmcnt(4)
    v_mfma_f32_16x16x32_bf16 v[144:147], v[60:63], v[124:127], v[144:147]
    s_waitcnt lgkmcnt(3)
    v_mfma_f32_16x16x32_bf16 v[144:147], v[64:67], v[128:131], v[144:147]
    s_waitcnt lgkmcnt(2)
    v_mfma_f32_16x16x32_bf16 v[144:147], v[68:71], v[132:135], v[144:147]
    s_waitcnt lgkmcnt(1)
    v_mfma_f32_16x16x32_bf16 v[144:147], v[72:75], v[136:139], v[144:147]
    s_waitcnt lgkmcnt(0)
    v_mfma_f32_16x16x32_bf16 v[144:147], v[76:79], v[140:143], v[144:147]
    s_nop 7
    v_min_u32 v144, -2, v144
    v_min_u32 v145, -2, v145
    v_min_u32 v146, -2, v146
    v_min_u32 v147, -2, v147
    s_andn2_b64 exec, exec, s[60:61]
    s_cmp_eq_u32 s47, 1
    s_cbranch_scc0 LS_26
    buffer_store_dwordx4 v[144:147], v153, s[32:35], s66 offen
LS_27:
    s_mov_b64 exec, -1
L_WOD:
    s_cmp_ge_u32 s36, 28
    s_cbranch_scc1 L_FIN
    s_cmp_lt_u32 s3, 8
    s_cbranch_scc1 L_B2S
    s_cmp_ge_u32 s3, 10
    s_cbranch_scc1 L_TB3
L_B1S:
    s_mul_i32 s41, s45, 2176
    s_add_u32 s41, s41, 655360
    s_setprio 0
L_B1:
    buffer_load_dwordx4 v[136:139], v15, s[32:35], s41 offen sc1
    buffer_load_dwordx4 v[140:143], v15, s[32:35], s41 offen offset:1024 sc1
    s_waitcnt vmcnt(0)
    v_max3_u32 v8, v136, v137, v138
    v_max3_u32 v8, v8, v139, v140
    v_max3_u32 v8, v8, v141, v142
    v_max_u32 v8, v8, v143
    v_cmp_eq_u32 vcc, -1, v8
    s_cbranch_vccnz LR_28
LC_29:
    s_setprio 3
    s_mov_b64 exec, -1
    v_permlane32_swap_b32 v136, v140
    v_permlane32_swap_b32 v137, v141
    v_permlane32_swap_b32 v138, v142
    v_permlane32_swap_b32 v139, v143
    v_pk_add_f32 v[136:137], v[136:137], v[140:141]
    v_pk_add_f32 v[138:139], v[138:139], v[142:143]
    s_nop 1
    v_permlane16_swap_b32 v136, v138
    v_permlane16_swap_b32 v137, v139
    v_pk_add_f32 v[136:137], v[136:137], v[138:139]
    s_nop 1
    v_add_f32_dpp v136, v136, v136 row_ror:8 row_mask:0xf bank_mask:0xf
    v_add_f32_dpp v137, v137, v137 row_ror:8 row_mask:0xf bank_mask:0xf
    v_cvt_pk_bf16_f32 v8, v136, v137
    v_lshlrev_b32 v136, 16, v8
    v_and_b32 v137, 0xffff0000, v8
    v_pk_mul_f32 v[136:137], v[136:137], v[152:153]
    v_cvt_pk_bf16_f32 v8, v136, v137
    v_lshlrev_b32 v136, 16, v8
    v_and_b32 v137, 0xffff0000, v8
    v_pk_add_f32 v[136:137], v[136:137], v[156:157]
    v_cvt_pk_bf16_f32 v138, v136, v137
    v_min_u32 v138, -2, v138
    s_andn2_b64 exec, exec, s[60:61]
    s_cmp_eq_u32 s47, 1
    s_cbranch_scc0 LS_30
    buffer_store_dword v138, v12, s[32:35], s67 offen
LS_31:
    s_mov_b64 exec, -1
    v_lshlrev_b32 v158, 16, v138
    v_and_b32 v159, 0xffff0000, v138
    s_branch L_TB3
L_PAD0:
    s_branch L_PAD1
L_B2S:
    v_lshrrev_b32 v11, 2, v0
    v_lshlrev_b32 v11, 9, v11
    v_and_b32 v12, 1, v0
    v_lshl_add_u32 v11, v12, 8, v11
    v_bfe_u32 v12, v0, 1, 1
    v_lshl_add_u32 v11, v12, 3, v11
    s_lshl_b32 s42, s3, 4
    v_add_u32 v144, s42, v11
    s_lshl_b32 s41, s3, 10
    s_add_u32 s41, s41, 57344
    v_mov_b32 v136, 0
    v_mov_b32 v137, 0
    v_mov_b32 v138, 0
    v_mov_b32 v139, 0
    v_mov_b32 v145, 0x3f803f80
    v_mov_b32 v146, 0x3b124925
    s_mul_i32 s44, s3, 896
    s_add_u32 s44, s44, 77568
    v_add_u32 v8, s44, v15
    v_add_u32 v9, 65552, v8
    ds_read_b128 v[160:163], v8
    ds_read_b128 v[164:167], v9
    s_waitcnt lgkmcnt(0)
    v_lshlrev_b32 v16, 16, v160
    v_and_b32 v17, 0xffff0000, v160
    v_add_f32 v16, 1.0, v16
    v_add_f32 v17, 1.0, v17
    v_cvt_pk_bf16_f32 v8, v16, v17
    v_lshlrev_b32 v16, 16, v8
    v_and_b32 v17, 0xffff0000, v8
    v_lshlrev_b32 v24, 16, v164
    v_and_b32 v25, 0xffff0000, v164
    v_lshlrev_b32 v18, 16, v161
    v_and_b32 v19, 0xffff0000, v161
    v_add_f32 v18, 1.0, v18
    v_add_f32 v19, 1.0, v19
    v_cvt_pk_bf16_f32 v8, v18, v19
    v_lshlrev_b32 v18, 16, v8
    v_and_b32 v19, 0xffff0000, v8
    v_lshlrev_b32 v26, 16, v165
    v_and_b32 v27, 0xffff0000, v165
    v_lshlrev_b32 v20, 16, v162
    v_and_b32 v21, 0xffff0000, v162
    v_add_f32 v20, 1.0, v20
    v_add_f32 v21, 1.0, v21
    v_cvt_pk_bf16_f32 v8, v20, v21
    v_lshlrev_b32 v20, 16, v8
    v_and_b32 v21, 0xffff0000, v8
    v_lshlrev_b32 v28, 16, v166
    v_and_b32 v29, 0xffff0000, v166
    v_lshlrev_b32 v22, 16, v163
    v_and_b32 v23, 0xffff0000, v163
    v_add_f32 v22, 1.0, v22
    v_add_f32 v23, 1.0, v23
    v_cvt_pk_bf16_f32 v8, v22, v23
    v_lshlrev_b32 v22, 16, v8
    v_and_b32 v23, 0xffff0000, v8
    v_lshlrev_b32 v30, 16, v167
    v_and_b32 v31, 0xffff0000, v167
    s_mov_b32 exec_hi, 0x00ffffff
    s_setprio 0
L_B2:
    buffer_load_dwordx4 v[136:139], v15, s[32:35], s41 offen sc1
    s_waitcnt vmcnt(0)
    v_max3_u32 v8, v136, v137, v138
    v_max_u32 v8, v8, v139
    v_cmp_eq_u32 vcc, -1, v8
    s_cbranch_vccnz LR_32
LC_33:
    s_setprio 3
    s_mov_b64 exec, -1
    v_dot2_f32_bf16 v8, v136, v145, 0
    v_dot2_f32_bf16 v9, v136, v136, 0
    v_dot2_f32_bf16 v8, v137, v145, v8
    v_dot2_f32_bf16 v9, v137, v137, v9
    v_dot2_f32_bf16 v8, v138, v145, v8
    v_dot2_f32_bf16 v9, v138, v138, v9
    v_dot2_f32_bf16 v8, v139, v145, v8
    v_dot2_f32_bf16 v9, v139, v139, v9
    v_lshlrev_b32 v128, 16, v136
    v_and_b32 v129, 0xffff0000, v136
    v_lshlrev_b32 v130, 16, v137
    v_and_b32 v131, 0xffff0000, v137
    v_add_f32_dpp v8, v8, v8 row_shr:1 row_mask:0xf bank_mask:0xf bound_ctrl:0
    v_add_f32_dpp v9, v9, v9 row_shr:1 row_mask:0xf bank_mask:0xf bound_ctrl:0
    v_lshlrev_b32 v132, 16, v138
    v_add_f32_dpp v8, v8, v8 row_shr:2 row_mask:0xf bank_mask:0xf bound_ctrl:0
    v_add_f32_dpp v9, v9, v9 row_shr:2 row_mask:0xf bank_mask:0xf bound_ctrl:0
    v_and_b32 v133, 0xffff0000, v138
    v_add_f32_dpp v8, v8, v8 row_shr:4 row_mask:0xf bank_mask:0xf bound_ctrl:0
    v_add_f32_dpp v9, v9, v9 row_shr:4 row_mask:0xf bank_mask:0xf bound_ctrl:0
    v_lshlrev_b32 v134, 16, v139
    v_add_f32_dpp v8, v8, v8 row_shr:8 row_mask:0xf bank_mask:0xf bound_ctrl:0
    v_add_f32_dpp v9, v9, v9 row_shr:8 row_mask:0xf bank_mask:0xf bound_ctrl:0
    v_and_b32 v135, 0xffff0000, v139
    v_add_f32_dpp v8, v8, v8 row_bcast:15 row_mask:0xa bank_mask:0xf
    v_add_f32_dpp v9, v9, v9 row_bcast:15 row_mask:0xa bank_mask:0xf
    s_nop 0
    v_add_f32_dpp v8, v8, v8 row_bcast:31 row_mask:0xc bank_mask:0xf
    v_add_f32_dpp v9, v9, v9 row_bcast:31 row_mask:0xc bank_mask:0xf
    v_readlane_b32 s42, v8, 63
    v_readlane_b32 s43, v9, 63
    s_nop 0
    v_mul_f32 v10, s42, v146
    v_mul_f32 v11, s43, v146
    v_fma_f32 v11, -v10, v10, v11
    v_max_f32 v11, 0, v11
    v_cvt_pk_bf16_f32 v8, v10, v11
    v_lshlrev_b32 v10, 16, v8
    v_and_b32 v11, 0xffff0000, v8
    v_add_f32 v11, 0x3727c5ac, v11
    v_sub_f32 v128, v128, v10
    v_cvt_pk_bf16_f32 v11, v11, v11
    v_sub_f32 v129, v129, v10
    v_lshlrev_b32 v11, 16, v11
    v_sub_f32 v130, v130, v10
    v_sqrt_f32 v11, v11
    v_sub_f32 v131, v131, v10
    v_sub_f32 v132, v132, v10
    v_cvt_pk_bf16_f32 v11, v11, v11
    v_sub_f32 v133, v133, v10
    v_lshlrev_b32 v11, 16, v11
    v_sub_f32 v134, v134, v10
    v_rcp_f32 v11, v11
    v_sub_f32 v135, v135, v10
    v_mul_f32 v128, v128, v11
    v_mul_f32 v129, v129, v11
    v_mul_f32 v130, v130, v11
    v_mul_f32 v131, v131, v11
    v_mul_f32 v132, v132, v11
    v_mul_f32 v133, v133, v11
    v_mul_f32 v134, v134, v11
    v_mul_f32 v135, v135, v11
    v_fma_f32 v128, v128, v16, v24
    v_fma_f32 v129, v129, v17, v25
    v_fma_f32 v130, v130, v18, v26
    v_fma_f32 v131, v131, v19, v27
    v_fma_f32 v132, v132, v20, v28
    v_fma_f32 v133, v133, v21, v29
    v_fma_f32 v134, v134, v22, v30
    v_fma_f32 v135, v135, v23, v31
    v_cvt_pk_bf16_f32 v136, v128, v129
    v_cvt_pk_bf16_f32 v137, v130, v131
    v_cvt_pk_bf16_f32 v138, v132, v133
    v_cvt_pk_bf16_f32 v139, v134, v135
    s_mov_b32 exec_hi, 0x00ffffff
    ds_write_b64 v144, v[136:137] offset:0
    ds_write_b64 v144, v[138:139] offset:128
    s_mov_b64 exec, -1
    s_waitcnt lgkmcnt(0)
L_TB3:
    s_barrier
    s_cmp_ge_u32 s3, 8
    s_cbranch_scc1 L_W13
    s_cmp_eq_u32 s3, 7
    s_cbranch_scc1 L_FIN
    v_and_b32 v9, 7, v2
    v_mul_u32_u24 v8, 136, v9
    v_lshl_add_u32 v8, v1, 3, v8
    v_add_u32 v8, 15424, v8
    v_lshrrev_b32 v10, 3, v2
    v_lshl_add_u32 v10, v10, 2, v1
    v_mul_u32_u24 v10, 4224, v10
    v_lshl_add_u32 v9, v9, 4, v10
    s_mul_i32 s41, s3, 33792
    s_lshl_b32 s42, s36, 7
    s_add_u32 s41, s41, s42
    s_add_u32 s41, s41, 786432
    s_barrier
    ds_read2_b64 v[112:115], v8 offset0:0 offset1:4
    ds_read2_b64 v[116:119], v8 offset0:8 offset1:12
    s_waitcnt lgkmcnt(1)
    v_mfma_f32_16x16x32_bf16 v[128:131], v[80:83], v[112:115], 0
    v_mfma_f32_16x16x32_bf16 v[132:135], v[84:87], v[112:115], 0
    v_mfma_f32_16x16x32_bf16 v[136:139], v[88:91], v[112:115], 0
    v_mfma_f32_16x16x32_bf16 v[140:143], v[92:95], v[112:115], 0
    s_waitcnt lgkmcnt(0)
    v_mfma_f32_16x16x32_bf16 v[128:131], v[96:99], v[116:119], v[128:131]
    v_mfma_f32_16x16x32_bf16 v[132:135], v[100:103], v[116:119], v[132:135]
    v_mfma_f32_16x16x32_bf16 v[136:139], v[104:107], v[116:119], v[136:139]
    v_mfma_f32_16x16x32_bf16 v[140:143], v[108:111], v[116:119], v[140:143]
    s_nop 4
    v_cvt_pk_bf16_f32 v144, v128, v129
    v_cvt_pk_bf16_f32 v145, v130, v131
    v_cvt_pk_bf16_f32 v146, v132, v133
    v_cvt_pk_bf16_f32 v147, v134, v135
    v_cvt_pk_bf16_f32 v148, v136, v137
    v_cvt_pk_bf16_f32 v149, v138, v139
    v_cvt_pk_bf16_f32 v150, v140, v141
    v_cvt_pk_bf16_f32 v151, v142, v143
    v_cndmask_b32 v144, v144, v148, s[60:61]
    v_min_u32 v144, -2, v144
    v_cndmask_b32 v145, v145, v149, s[60:61]
    v_min_u32 v145, -2, v145
    v_cndmask_b32 v146, v146, v150, s[60:61]
    v_min_u32 v146, -2, v146
    v_cndmask_b32 v147, v147, v151, s[60:61]
    v_min_u32 v147, -2, v147
    s_cmp_eq_u32 s47, 1
    s_cbranch_scc0 LS_34
    buffer_store_dwordx4 v[144:147], v9, s[32:35], s41 offen
LS_35:
    s_branch L_FIN
L_PAD1:
    s_branch L_PAD2
L_W13:
    ds_read_b128 v[128:131], v14 offset:0
    ds_read_b128 v[132:135], v14 offset:512
    ds_read_b128 v[136:139], v14 offset:1024
    ds_read_b128 v[140:143], v14 offset:1536
    ds_read_b128 v[144:147], v14 offset:2048
    ds_read_b128 v[148:151], v14 offset:2560
    s_mov_b32 s44, 0xbfb8aa3b
    v_and_b32 v8, 7, v2
    v_mul_u32_u24 v8, 136, v8
    v_and_b32 v9, 1, v1
    v_lshl_add_u32 v8, v9, 3, v8
    v_lshrrev_b32 v9, 5, v0
    v_lshl_add_u32 v8, v9, 2, v8
    v_lshrrev_b32 v9, 3, v2
    v_lshl_add_u32 v8, v9, 4, v8
    s_sub_u32 s42, s3, 8
    s_lshl_b32 s42, s42, 5
    v_add_u32 v8, s42, v8
    s_waitcnt lgkmcnt(5)
    v_mfma_f32_16x16x32_bf16 v[160:163], v[16:19], v[128:131], 0
    v_mfma_f32_16x16x32_bf16 v[164:167], v[72:75], v[128:131], 0
    ds_read_b128 v[128:131], v14 offset:3072
    s_waitcnt lgkmcnt(5)
    v_mfma_f32_16x16x32_bf16 v[160:163], v[20:23], v[132:135], v[160:163]
    v_mfma_f32_16x16x32_bf16 v[164:167], v[76:79], v[132:135], v[164:167]
    ds_read_b128 v[132:135], v14 offset:3584
    s_waitcnt lgkmcnt(5)
    v_mfma_f32_16x16x32_bf16 v[160:163], v[24:27], v[136:139], v[160:163]
    v_mfma_f32_16x16x32_bf16 v[164:167], v[80:83], v[136:139], v[164:167]
    ds_read_b128 v[136:139], v14 offset:4096
    s_waitcnt lgkmcnt(5)
    v_mfma_f32_16x16x32_bf16 v[160:163], v[28:31], v[140:143], v[160:163]
    v_mfma_f32_16x16x32_bf16 v[164:167], v[84:87], v[140:143], v[164:167]
    ds_read_b128 v[140:143], v14 offset:4608
    s_waitcnt lgkmcnt(5)
    v_mfma_f32_16x16x32_bf16 v[160:163], v[32:35], v[144:147], v[160:163]
    v_mfma_f32_16x16x32_bf16 v[164:167], v[88:91], v[144:147], v[164:167]
    ds_read_b128 v[144:147], v14 offset:5120
    s_waitcnt lgkmcnt(5)
    v_mfma_f32_16x16x32_bf16 v[160:163], v[36:39], v[148:151], v[160:163]
    v_mfma_f32_16x16x32_bf16 v[164:167], v[92:95], v[148:151], v[164:167]
    ds_read_b128 v[148:151], v14 offset:5632
    s_waitcnt lgkmcnt(5)
    v_mfma_f32_16x16x32_bf16 v[160:163], v[40:43], v[128:131], v[160:163]
    v_mfma_f32_16x16x32_bf16 v[164:167], v[96:99], v[128:131], v[164:167]
    ds_read_b128 v[128:131], v14 offset:6144
    s_waitcnt lgkmcnt(5)
    v_mfma_f32_16x16x32_bf16 v[160:163], v[44:47], v[132:135], v[160:163]
    v_mfma_f32_16x16x32_bf16 v[164:167], v[100:103], v[132:135], v[164:167]
    ds_read_b128 v[132:135], v14 offset:6656
    s_waitcnt lgkmcnt(5)
    v_mfma_f32_16x16x32_bf16 v[160:163], v[48:51], v[136:139], v[160:163]
    v_mfma_f32_16x16x32_bf16 v[164:167], v[104:107], v[136:139], v[164:167]
    s_waitcnt lgkmcnt(4)
    v_mfma_f32_16x16x32_bf16 v[160:163], v[52:55], v[140:143], v[160:163]
    v_mfma_f32_16x16x32_bf16 v[164:167], v[108:111], v[140:143], v[164:167]
    s_waitcnt lgkmcnt(3)
    v_mfma_f32_16x16x32_bf16 v[160:163], v[56:59], v[144:147], v[160:163]
    v_mfma_f32_16x16x32_bf16 v[164:167], v[112:115], v[144:147], v[164:167]
    s_waitcnt lgkmcnt(2)
    v_mfma_f32_16x16x32_bf16 v[160:163], v[60:63], v[148:151], v[160:163]
    v_mfma_f32_16x16x32_bf16 v[164:167], v[116:119], v[148:151], v[164:167]
    s_waitcnt lgkmcnt(1)
    v_mfma_f32_16x16x32_bf16 v[160:163], v[64:67], v[128:131], v[160:163]
    v_mfma_f32_16x16x32_bf16 v[164:167], v[120:123], v[128:131], v[164:167]
    s_waitcnt lgkmcnt(0)
    v_mfma_f32_16x16x32_bf16 v[160:163], v[68:71], v[132:135], v[160:163]
    v_mfma_f32_16x16x32_bf16 v[164:167], v[124:127], v[132:135], v[164:167]
    s_nop 7
    v_cndmask_b32 v160, v160, v164, s[60:61]
    v_cndmask_b32 v161, v161, v165, s[60:61]
    v_cndmask_b32 v162, v162, v166, s[60:61]
    v_cndmask_b32 v163, v163, v167, s[60:61]
    s_nop 0
    v_permlane32_swap_b32 v160, v162
    v_permlane32_swap_b32 v161, v163
    v_cvt_pk_bf16_f32 v12, v160, v161
    v_lshlrev_b32 v160, 16, v12
    v_and_b32 v161, 0xffff0000, v12
    v_mul_f32 v10, s44, v160
    v_mul_f32 v11, s44, v161
    v_exp_f32 v10, v10
    v_exp_f32 v11, v11
    v_cvt_pk_bf16_f32 v12, v162, v163
    v_lshlrev_b32 v162, 16, v12
    v_and_b32 v163, 0xffff0000, v12
    v_add_f32 v10, 1.0, v10
    v_add_f32 v11, 1.0, v11
    v_rcp_f32 v10, v10
    v_rcp_f32 v11, v11
    v_mul_f32 v160, v160, v10
    v_mul_f32 v161, v161, v11
    v_cvt_pk_bf16_f32 v12, v160, v161
    v_lshlrev_b32 v160, 16, v12
    v_and_b32 v161, 0xffff0000, v12
    v_mul_f32 v160, v160, v162
    v_mul_f32 v161, v161, v163
    v_cvt_pk_bf16_f32 v10, v160, v161
    ds_write_b32 v8, v10 offset:15424
    s_waitcnt lgkmcnt(0)
    s_barrier
    s_cmp_ge_u32 s3, 10
    s_cbranch_scc1 L_FIN
    s_mul_i32 s41, s45, 4224
    s_add_u32 s41, s41, 786432
    v_mov_b32 v28, 0
    v_mov_b32 v29, 0
    v_mov_b32 v30, 0
    v_mov_b32 v31, 0
    s_setprio 0
L_FB:
    s_mov_b64 s[64:65], exec
    buffer_load_dwordx4 v[16:19], v15, s[32:35], s41 offen offset:0 sc1
    buffer_load_dwordx4 v[20:23], v15, s[32:35], s41 offen offset:1024 sc1
    buffer_load_dwordx4 v[24:27], v15, s[32:35], s41 offen offset:2048 sc1
    s_mov_b32 exec_hi, 0
    s_cbranch_execz L_FB2
    buffer_load_dwordx4 v[28:31], v15, s[32:35], s41 offen offset:3072 sc1
L_FB2:
    s_mov_b64 exec, s[64:65]
    s_waitcnt vmcnt(0)
    v_max3_u32 v8, v16, v17, v18
    v_max3_u32 v8, v8, v19, v20
    v_max3_u32 v8, v8, v21, v22
    v_max3_u32 v8, v8, v23, v24
    v_max3_u32 v8, v8, v25, v26
    v_max3_u32 v8, v8, v27, v28
    v_max3_u32 v8, v8, v29, v30
    v_max_u32 v8, v8, v31
    v_cmp_eq_u32 vcc, -1, v8
    s_cbranch_vccnz LR_36
LC_37:
    s_mov_b64 exec, -1
    s_setprio 3
    v_mov_b32 v8, 0x3f80
    v_mov_b32 v9, 0x3f800000
    v_dot2_f32_bf16 v32, v16, v8, 0
    v_dot2_f32_bf16 v33, v16, v9, 0
    v_dot2_f32_bf16 v34, v17, v8, 0
    v_dot2_f32_bf16 v35, v17, v9, 0
    v_dot2_f32_bf16 v36, v18, v8, 0
    v_dot2_f32_bf16 v37, v18, v9, 0
    v_dot2_f32_bf16 v38, v19, v8, 0
    v_dot2_f32_bf16 v39, v19, v9, 0
    v_dot2_f32_bf16 v32, v20, v8, v32
    v_dot2_f32_bf16 v33, v20, v9, v33
    v_dot2_f32_bf16 v34, v21, v8, v34
    v_dot2_f32_bf16 v35, v21, v9, v35
    v_dot2_f32_bf16 v36, v22, v8, v36
    v_dot2_f32_bf16 v37, v22, v9, v37
    v_dot2_f32_bf16 v38, v23, v8, v38
    v_dot2_f32_bf16 v39, v23, v9, v39
    v_dot2_f32_bf16 v32, v24, v8, v32
    v_dot2_f32_bf16 v33, v24, v9, v33
    v_dot2_f32_bf16 v34, v25, v8, v34
    v_dot2_f32_bf16 v35, v25, v9, v35
    v_dot2_f32_bf16 v36, v26, v8, v36
    v_dot2_f32_bf16 v37, v26, v9, v37
    v_dot2_f32_bf16 v38, v27, v8, v38
    v_dot2_f32_bf16 v39, v27, v9, v39
    v_dot2_f32_bf16 v32, v28, v8, v32
    v_dot2_f32_bf16 v33, v28, v9, v33
    v_dot2_f32_bf16 v34, v29, v8, v34
    v_dot2_f32_bf16 v35, v29, v9, v35
    v_dot2_f32_bf16 v36, v30, v8, v36
    v_dot2_f32_bf16 v37, v30, v9, v37
    v_dot2_f32_bf16 v38, v31, v8, v38
    v_dot2_f32_bf16 v39, v31, v9, v39
    s_nop 2
    v_permlane32_swap_b32 v32, v36
    v_permlane32_swap_b32 v33, v37
    v_permlane32_swap_b32 v34, v38
    v_permlane32_swap_b32 v35, v39
    v_pk_add_f32 v[32:33], v[32:33], v[36:37]
    v_pk_add_f32 v[34:35], v[34:35], v[38:39]
    s_nop 1
    v_permlane16_swap_b32 v32, v34
    v_permlane16_swap_b32 v33, v35
    v_pk_add_f32 v[32:33], v[32:33], v[34:35]
    s_nop 1
    v_add_f32_dpp v32, v32, v32 row_ror:8 row_mask:0xf bank_mask:0xf
    v_add_f32_dpp v33, v33, v33 row_ror:8 row_mask:0xf bank_mask:0xf
    v_cvt_pk_bf16_f32 v8, v32, v33
    v_lshlrev_b32 v32, 16, v8
    v_and_b32 v33, 0xffff0000, v8
    v_pk_mul_f32 v[32:33], v[32:33], v[154:155]
    v_cvt_pk_bf16_f32 v8, v32, v33
    v_lshlrev_b32 v32, 16, v8
    v_and_b32 v33, 0xffff0000, v8
    v_pk_add_f32 v[32:33], v[32:33], v[158:159]
    v_cvt_pk_bf16_f32 v16, v32, v33
    s_andn2_b64 exec, exec, s[60:61]
    buffer_store_dword v16, v13, s[56:59], s66 offen
    s_mov_b64 exec, -1
L_FIN:
L_END:
    s_endpgm
L_PAD2:
    s_branch L_T22
LR_1:
    s_mov_b64 exec, vcc
    s_sleep 4
    s_add_u32 s40, s40, 1
    s_cmp_lt_u32 s40, 400000
    s_cbranch_scc1 L_MU
    s_branch LC_2
LS_14:
    buffer_store_dwordx4 v[8:11], v15, s[32:35], s41 offen offset:0 sc1
    buffer_store_dwordx4 v[8:11], v15, s[32:35], s41 offen offset:1024 sc1
    buffer_store_dwordx4 v[8:11], v15, s[32:35], s41 offen offset:2048 sc1
    buffer_store_dwordx4 v[8:11], v15, s[32:35], s41 offen offset:3072 sc1
    s_nop 1
    s_branch LS_15
LS_16:
    buffer_store_dwordx4 v[8:11], v15, s[32:35], s41 offen sc1
    s_nop 1
    s_branch LS_17
LS_26:
    buffer_store_dwordx4 v[144:147], v153, s[32:35], s66 offen sc1
    s_nop 1
    s_branch LS_27
LR_28:
    s_mov_b64 exec, vcc
    s_add_u32 s40, s40, 1
    s_cmp_lt_u32 s40, 400000
    s_cbranch_scc1 L_B1
    s_branch LC_29
LS_30:
    buffer_store_dword v138, v12, s[32:35], s67 offen sc1
    s_nop 1
    s_branch LS_31
LR_32:
    s_mov_b64 exec, vcc
    s_add_u32 s40, s40, 1
    s_cmp_lt_u32 s40, 400000
    s_cbranch_scc1 L_B2
    s_branch LC_33
LS_34:
    buffer_store_dwordx4 v[144:147], v9, s[32:35], s41 offen sc1
    s_nop 1
    s_branch LS_35
LR_36:
    s_mov_b64 exec, vcc
    s_add_u32 s40, s40, 1
    s_cmp_lt_u32 s40, 400000
    s_cbranch_scc1 L_FB
    s_branch LC_37
L_CODE_END:

.section .rodata,"a"
.p2align 6
.amdhsa_kernel adaLN_cond__sliding_block_cached__glu_gated_swiglu__decode_kernel
  .amdhsa_next_free_vgpr 168
  .amdhsa_next_free_sgpr 102
  .amdhsa_accum_offset 168
  .amdhsa_group_segment_fixed_size 0
  .amdhsa_kernarg_size 112
  .amdhsa_user_sgpr_count 2
  .amdhsa_user_sgpr_kernarg_segment_ptr 1
  .amdhsa_system_sgpr_workgroup_id_x 1
.end_amdhsa_kernel
```
